```python
import torch

def _softmax(x, axis=-1):
    return torch.softmax(x, dim=axis)
def _gelu(x):
    return torch.nn.functional.gelu(x, approximate="tanh")
def _silu(x):
    return torch.nn.functional.silu(x)
def _sigmoid(x):
    return torch.sigmoid(x)
def _layernorm(x, axis=-1, eps=1e-5):
    m = x.mean(dim=axis, keepdim=True)
    v = x.var(dim=axis, keepdim=True, unbiased=False)
    return (x - m) / torch.sqrt(v + eps)
def _scatter_add(tgt, idx, src, axis=0):
    return tgt.clone().index_add_(axis, idx, src)
def _segment_sum(src, seg, n):
    out = torch.zeros((n,) + src.shape[1:], dtype=src.dtype)
    return out.index_add_(0, seg, src)
def _pad(x, pw):
    flat = tuple(v for pair in reversed(pw) for v in pair)
    return torch.nn.functional.pad(x, flat)

kernel_name = 'standalone__mha_softmax__prompt'

def setup_inputs():

    _w = (lambda a: (lambda t: t.to(torch.bfloat16) if t.is_floating_point() else t)(torch.as_tensor(a)))
    B, H, Sq, Sk, D = 1, 32, 2048, 2048, 192
    return {
        "q": _w((lambda *s: torch.randn(*s, dtype=torch.bfloat16) * 0.8)(B, H, Sq, D)),
        "k": _w((lambda *s: torch.randn(*s, dtype=torch.bfloat16) * 0.8)(B, H, Sk, D)),
        "v": _w((lambda *s: torch.randn(*s, dtype=torch.bfloat16) * 0.05)(B, H, Sk, D)),
    }

def reference(q, k, v):
    scale = q.shape[-1] ** -0.5
    scores = torch.einsum("bhqd,bhkd->bhqk", q, k) * scale
    p = _softmax(scores, axis=-1)
    return torch.einsum("bhqk,bhkd->bhqd", p, v)
```

```asm
; @launch grid=(256,1,1) block=(256,1,1) lds=156928
.amdgcn_target "amdgcn-amd-amdhsa--gfx950"
.text
.globl standalone__mha_softmax__prompt_kernel
.p2align 8
.type standalone__mha_softmax__prompt_kernel,@function
standalone__mha_softmax__prompt_kernel:
    s_cmp_ge_u32 s2, 256
    s_cbranch_scc1 L_end
    s_load_dwordx4 s[4:7], s[0:1], 0
    s_load_dwordx4 s[40:43], s[0:1], 16
    v_lshrrev_b32 v0, 6, v0
    s_and_b32 s3, s2, 7
    s_lshl_b32 s3, s3, 2
    s_lshr_b32 s44, s2, 6
    v_readfirstlane_b32 s33, v0
    s_add_u32 s3, s3, s44
    s_mul_i32 s3, s3, 786432
    s_lshr_b32 s44, s2, 3
    s_and_b32 s44, s44, 7
    s_lshl_b32 s44, s44, 2
    s_add_u32 s44, s44, s33
    s_mul_i32 s44, s44, 24576
    s_add_u32 s44, s44, s3
    s_mul_i32 s60, s33, 6144
    s_mov_b32 s62, 0x3dd53b95
    s_mov_b32 s63, 0x3dd53b95
    s_mov_b32 s39, 0xffff0000
    s_mov_b32 s45, 6144
    s_mov_b32 s46, 12288
    s_mov_b32 s47, 18432
    s_mov_b32 s35, 0
    v_mov_b32 v204, 0
    v_mov_b32 v205, 0
    v_mov_b32 v206, 0
    v_mov_b32 v207, 0
    v_mbcnt_lo_u32_b32 v220, -1, 0
    v_mbcnt_hi_u32_b32 v220, -1, v220
    v_add_u32 v221, 0, v220
    v_mfma_f32_32x32x16_bf16 a[0:15], v[204:207], v[204:207], 0
    v_mul_u32_u24 v221, 2731, v221
    v_lshrrev_b32 v221, 16, v221
    v_and_b32 v221, 6, v221
    v_xor_b32 v221, v221, v220
    v_lshl_add_u32 v214, v221, 4, s60
    v_add_u32 v221, 64, v220
    v_mul_u32_u24 v221, 2731, v221
    v_mfma_f32_32x32x16_bf16 a[16:31], v[204:207], v[204:207], 0
    v_lshrrev_b32 v221, 16, v221
    v_and_b32 v221, 6, v221
    v_xor_b32 v221, v221, v220
    v_lshl_add_u32 v215, v221, 4, s60
    v_add_u32 v221, 0x80, v220
    v_mul_u32_u24 v221, 2731, v221
    v_lshrrev_b32 v221, 16, v221
    v_mfma_f32_32x32x16_bf16 a[32:47], v[204:207], v[204:207], 0
    v_and_b32 v221, 6, v221
    v_xor_b32 v221, v221, v220
    v_lshl_add_u32 v216, v221, 4, s60
    v_lshrrev_b32 v221, 3, v220
    v_and_b32 v222, 7, v220
    v_mul_u32_u24 v217, 0x180, v221
    v_lshl_add_u32 v217, v222, 4, v217
    v_mfma_f32_32x32x16_bf16 a[48:63], v[204:207], v[204:207], 0
    s_lshl_b32 s36, s33, 11
    s_add_u32 s36, s36, 148736
    v_xor_b32 v1, v221, v220
    v_lshl_add_u32 v1, v1, 4, s36
    v_lshrrev_b32 v221, 4, v220
    v_xor_b32 v221, v221, v222
    v_lshl_add_u32 v221, v221, 4, s36
    v_mfma_f32_32x32x16_bf16 a[64:79], v[204:207], v[204:207], 0
    v_and_b32 v222, 15, v220
    v_lshl_add_u32 v2, v222, 7, v221
    v_xor_b32 v3, 64, v2
    v_and_b32 v224, 15, v220
    v_lshrrev_b32 v221, 4, v220
    v_and_b32 v222, 6, v224
    v_xor_b32 v221, v221, v222
    v_mfma_f32_32x32x16_bf16 a[80:95], v[204:207], v[204:207], 0
    v_mul_u32_u24 v223, 0x180, v224
    v_lshl_add_u32 v208, v221, 4, v223
    v_xor_b32 v221, 4, v221
    v_lshl_add_u32 v209, v221, 4, v223
    v_lshrrev_b32 v224, 2, v220
    v_mul_u32_u24 v223, 0x180, v224
    v_and_b32 v221, 1, v220
    v_mfma_f32_32x32x16_bf16 a[96:111], v[204:207], v[204:207], 0
    v_lshl_add_u32 v223, v221, 3, v223
    v_add_u32 v223, 73728, v223
    v_bfe_u32 v221, v220, 1, 1
    v_and_b32 v222, 6, v224
    v_xor_b32 v221, v221, v222
    v_xor_b32 v222, 0, v221
    v_lshl_add_u32 v210, v222, 4, v223
    v_mfma_f32_32x32x16_bf16 a[112:127], v[204:207], v[204:207], 0
    v_xor_b32 v222, 2, v221
    v_lshl_add_u32 v211, v222, 4, v223
    v_xor_b32 v222, 4, v221
    v_lshl_add_u32 v212, v222, 4, v223
    v_xor_b32 v222, 6, v221
    v_lshl_add_u32 v213, v222, 4, v223
    v_mov_b32 v252, 0
    v_mov_b32 v253, 0
    v_mov_b32 v254, 0
    v_mov_b32 v255, 0
    v_and_b32 v221, 14, v220
    v_mov_b32 v222, 0x3f803f80
    v_cmp_eq_u32 vcc, 0, v221
    v_cndmask_b32 v244, 0, v222, vcc
    v_cndmask_b32 v245, 0, v222, vcc
    v_cndmask_b32 v246, 0, v222, vcc
    v_cndmask_b32 v247, 0, v222, vcc
    v_cmp_eq_u32 vcc, 2, v221
    v_cndmask_b32 v248, 0, v222, vcc
    v_cndmask_b32 v249, 0, v222, vcc
    v_cndmask_b32 v250, 0, v222, vcc
    v_cndmask_b32 v251, 0, v222, vcc
    v_and_b32 v221, 1, v220
    v_mul_u32_u24 v221, 0xaaaa, v221
    v_add_u32 v218, 0x4444, v221
    s_mov_b32 s10, 24576
    s_mov_b32 s11, 0x20000
    s_mov_b32 s14, 786432
    s_mov_b32 s15, 0x20000
    s_mov_b32 s18, 786432
    s_mov_b32 s19, 0x20000
    s_mov_b32 s22, 24576
    s_mov_b32 s23, 0x20000
    s_waitcnt lgkmcnt(0)
    s_add_u32 s12, s6, s3
    s_addc_u32 s13, s7, 0
    s_add_u32 s8, s4, s44
    s_addc_u32 s9, s5, 0
    s_add_u32 s16, s40, s3
    s_addc_u32 s17, s41, 0
    s_add_u32 s20, s42, s44
    s_addc_u32 s21, s43, 0
    s_sub_u32 s44, s44, s60
    s_add_u32 s44, s44, 12288
    s_add_u32 s48, s4, s44
    s_addc_u32 s49, s5, 0
    s_add_u32 s50, s60, 12288
    s_mov_b32 s51, 0x20000
    s_mov_b32 s24, 737280
    s_mov_b32 s26, 740352
    s_add_u32 s28, s60, 0
    s_mov_b32 m0, s28
    s_nop 0
    buffer_load_dwordx4 v214, s[12:15], s24 offen offset:0 lds
    buffer_load_dwordx4 v215, s[12:15], s24 offen offset:1024 lds
    buffer_load_dwordx4 v216, s[12:15], s24 offen offset:2048 lds
    s_add_u32 m0, s28, 3072
    s_nop 0
    buffer_load_dwordx4 v214, s[12:15], s26 offen offset:0 lds
    buffer_load_dwordx4 v215, s[12:15], s26 offen offset:1024 lds
    buffer_load_dwordx4 v216, s[12:15], s26 offen offset:2048 lds
    buffer_load_dwordx4 v[52:55], v217, s[8:11], 0 offen offset:0
    buffer_load_dwordx4 v[56:59], v217, s[8:11], 0 offen offset:3072
    buffer_load_dwordx4 v[60:63], v217, s[8:11], 0 offen offset:128
    buffer_load_dwordx4 v[64:67], v217, s[8:11], 0 offen offset:3200
    buffer_load_dwordx4 v[84:87], v217, s[8:11], 0 offen offset:256
    buffer_load_dwordx4 v[88:91], v217, s[8:11], 0 offen offset:3328
    buffer_load_dwordx4 v[92:95], v217, s[8:11], s45 offen offset:0
    buffer_load_dwordx4 v[96:99], v217, s[8:11], s45 offen offset:3072
    buffer_load_dwordx4 v[100:103], v217, s[8:11], s45 offen offset:128
    buffer_load_dwordx4 v[104:107], v217, s[8:11], s45 offen offset:3200
    buffer_load_dwordx4 v[108:111], v217, s[8:11], s45 offen offset:256
    buffer_load_dwordx4 v[112:115], v217, s[8:11], s45 offen offset:3328
    v_mfma_f32_32x32x16_bf16 a[128:143], v[204:207], v[204:207], 0
    v_mfma_f32_32x32x16_bf16 a[144:159], v[204:207], v[204:207], 0
    v_mfma_f32_32x32x16_bf16 a[160:175], v[204:207], v[204:207], 0
    v_mfma_f32_32x32x16_bf16 a[176:191], v[204:207], v[204:207], 0
    v_mov_b32 v196, 0x7f800000
    v_mov_b32 v197, 0x7f800000
    v_mov_b32 v198, 0x7f800000
    v_mov_b32 v199, 0x7f800000
    v_mov_b32 v200, 0x7f800000
    v_mov_b32 v201, 0x7f800000
    v_mov_b32 v202, 0x7f800000
    v_mov_b32 v203, 0x7f800000
    s_waitcnt vmcnt(12)
    s_barrier
    ds_read_b128 v[116:119], v208 offset:0
    ds_read_b128 v[120:123], v209 offset:0
    ds_read_b128 v[124:127], v208 offset:128
    ds_read_b128 v[128:131], v209 offset:128
    ds_read_b128 v[132:135], v208 offset:256
    ds_read_b128 v[136:139], v209 offset:256
    s_waitcnt vmcnt(11)
    v_lshlrev_b32 v220, 16, v52
    v_and_b32 v221, s39, v52
    v_lshlrev_b32 v222, 16, v53
    v_and_b32 v223, s39, v53
    v_lshlrev_b32 v224, 16, v54
    v_and_b32 v225, s39, v54
    v_lshlrev_b32 v226, 16, v55
    v_and_b32 v227, s39, v55
    v_pk_mul_f32 v[220:221], s[62:63], v[220:221]
    v_pk_mul_f32 v[222:223], s[62:63], v[222:223]
    v_pk_mul_f32 v[224:225], s[62:63], v[224:225]
    v_pk_mul_f32 v[226:227], s[62:63], v[226:227]
    v_cvt_pk_bf16_f32 v52, v220, v221
    v_cvt_pk_bf16_f32 v53, v222, v223
    v_cvt_pk_bf16_f32 v54, v224, v225
    v_cvt_pk_bf16_f32 v55, v226, v227
    ds_write_b128 v1, v[52:55] offset:0
    s_mov_b32 s25, 737280
    s_mov_b32 s27, 740352
    s_add_u32 s29, s60, 73728
    s_mov_b32 m0, s29
    s_nop 0
    buffer_load_dwordx4 v214, s[16:19], s25 offen offset:0 lds
    s_waitcnt vmcnt(11)
    v_lshlrev_b32 v228, 16, v56
    v_and_b32 v229, s39, v56
    v_lshlrev_b32 v230, 16, v57
    v_and_b32 v231, s39, v57
    v_lshlrev_b32 v232, 16, v58
    v_and_b32 v233, s39, v58
    v_lshlrev_b32 v234, 16, v59
    v_and_b32 v235, s39, v59
    v_pk_mul_f32 v[228:229], s[62:63], v[228:229]
    v_pk_mul_f32 v[230:231], s[62:63], v[230:231]
    v_pk_mul_f32 v[232:233], s[62:63], v[232:233]
    v_pk_mul_f32 v[234:235], s[62:63], v[234:235]
    v_cvt_pk_bf16_f32 v56, v228, v229
    v_cvt_pk_bf16_f32 v57, v230, v231
    v_cvt_pk_bf16_f32 v58, v232, v233
    v_cvt_pk_bf16_f32 v59, v234, v235
    ds_write_b128 v1, v[56:59] offset:1024
    ds_read_b128 a[192:195], v2
    ds_read_b128 a[196:199], v3
    buffer_load_dwordx4 v215, s[16:19], s25 offen offset:1024 lds
    s_waitcnt vmcnt(11)
    v_lshlrev_b32 v220, 16, v60
    v_and_b32 v221, s39, v60
    v_lshlrev_b32 v222, 16, v61
    v_and_b32 v223, s39, v61
    v_lshlrev_b32 v224, 16, v62
    v_and_b32 v225, s39, v62
    v_lshlrev_b32 v226, 16, v63
    v_and_b32 v227, s39, v63
    v_pk_mul_f32 v[220:221], s[62:63], v[220:221]
    v_pk_mul_f32 v[222:223], s[62:63], v[222:223]
    v_pk_mul_f32 v[224:225], s[62:63], v[224:225]
    v_pk_mul_f32 v[226:227], s[62:63], v[226:227]
    v_cvt_pk_bf16_f32 v60, v220, v221
    v_cvt_pk_bf16_f32 v61, v222, v223
    v_cvt_pk_bf16_f32 v62, v224, v225
    v_cvt_pk_bf16_f32 v63, v226, v227
    ds_write_b128 v1, v[60:63] offset:0
    buffer_load_dwordx4 v216, s[16:19], s25 offen offset:2048 lds
    s_waitcnt vmcnt(11)
    v_lshlrev_b32 v228, 16, v64
    v_and_b32 v229, s39, v64
    v_lshlrev_b32 v230, 16, v65
    v_and_b32 v231, s39, v65
    v_lshlrev_b32 v232, 16, v66
    v_and_b32 v233, s39, v66
    v_lshlrev_b32 v234, 16, v67
    v_and_b32 v235, s39, v67
    v_pk_mul_f32 v[228:229], s[62:63], v[228:229]
    v_pk_mul_f32 v[230:231], s[62:63], v[230:231]
    v_pk_mul_f32 v[232:233], s[62:63], v[232:233]
    v_pk_mul_f32 v[234:235], s[62:63], v[234:235]
    v_cvt_pk_bf16_f32 v64, v228, v229
    v_cvt_pk_bf16_f32 v65, v230, v231
    v_cvt_pk_bf16_f32 v66, v232, v233
    v_cvt_pk_bf16_f32 v67, v234, v235
    ds_write_b128 v1, v[64:67] offset:1024
    ds_read_b128 a[200:203], v2
    ds_read_b128 a[204:207], v3
    s_add_u32 m0, s29, 3072
    s_nop 0
    buffer_load_dwordx4 v214, s[16:19], s27 offen offset:0 lds
    s_waitcnt vmcnt(11)
    v_lshlrev_b32 v220, 16, v84
    v_and_b32 v221, s39, v84
    v_lshlrev_b32 v222, 16, v85
    v_and_b32 v223, s39, v85
    v_lshlrev_b32 v224, 16, v86
    v_and_b32 v225, s39, v86
    v_lshlrev_b32 v226, 16, v87
    v_and_b32 v227, s39, v87
    v_pk_mul_f32 v[220:221], s[62:63], v[220:221]
    v_pk_mul_f32 v[222:223], s[62:63], v[222:223]
    v_pk_mul_f32 v[224:225], s[62:63], v[224:225]
    v_pk_mul_f32 v[226:227], s[62:63], v[226:227]
    v_cvt_pk_bf16_f32 v84, v220, v221
    v_cvt_pk_bf16_f32 v85, v222, v223
    v_cvt_pk_bf16_f32 v86, v224, v225
    v_cvt_pk_bf16_f32 v87, v226, v227
    ds_write_b128 v1, v[84:87] offset:0
    buffer_load_dwordx4 v215, s[16:19], s27 offen offset:1024 lds
    s_waitcnt vmcnt(11)
    v_lshlrev_b32 v228, 16, v88
    v_and_b32 v229, s39, v88
    v_lshlrev_b32 v230, 16, v89
    v_and_b32 v231, s39, v89
    v_lshlrev_b32 v232, 16, v90
    v_and_b32 v233, s39, v90
    v_lshlrev_b32 v234, 16, v91
    v_and_b32 v235, s39, v91
    v_pk_mul_f32 v[228:229], s[62:63], v[228:229]
    v_pk_mul_f32 v[230:231], s[62:63], v[230:231]
    v_pk_mul_f32 v[232:233], s[62:63], v[232:233]
    v_pk_mul_f32 v[234:235], s[62:63], v[234:235]
    v_cvt_pk_bf16_f32 v88, v228, v229
    v_cvt_pk_bf16_f32 v89, v230, v231
    v_cvt_pk_bf16_f32 v90, v232, v233
    v_cvt_pk_bf16_f32 v91, v234, v235
    ds_write_b128 v1, v[88:91] offset:1024
    ds_read_b128 a[208:211], v2
    ds_read_b128 a[212:215], v3
    buffer_load_dwordx4 v216, s[16:19], s27 offen offset:2048 lds
    s_waitcnt vmcnt(11)
    v_lshlrev_b32 v220, 16, v92
    v_and_b32 v221, s39, v92
    v_lshlrev_b32 v222, 16, v93
    v_and_b32 v223, s39, v93
    v_lshlrev_b32 v224, 16, v94
    v_and_b32 v225, s39, v94
    v_lshlrev_b32 v226, 16, v95
    v_and_b32 v227, s39, v95
    v_pk_mul_f32 v[220:221], s[62:63], v[220:221]
    v_pk_mul_f32 v[222:223], s[62:63], v[222:223]
    v_pk_mul_f32 v[224:225], s[62:63], v[224:225]
    v_pk_mul_f32 v[226:227], s[62:63], v[226:227]
    v_cvt_pk_bf16_f32 v92, v220, v221
    v_cvt_pk_bf16_f32 v93, v222, v223
    v_cvt_pk_bf16_f32 v94, v224, v225
    v_cvt_pk_bf16_f32 v95, v226, v227
    ds_write_b128 v1, v[92:95] offset:0
    s_mov_b32 s24, 761856
    s_mov_b32 s26, 764928
    s_add_u32 s28, s60, 24576
    s_mov_b32 m0, s28
    s_nop 0
    buffer_load_dwordx4 v214, s[12:15], s24 offen offset:0 lds
    s_waitcnt lgkmcnt(10)
    v_mfma_f32_16x16x32_bf16 v[36:39], v[116:119], a[192:195], 0
    s_waitcnt lgkmcnt(9)
    v_mfma_f32_16x16x32_bf16 v[36:39], v[120:123], a[196:199], v[36:39]
    s_waitcnt lgkmcnt(6)
    v_mfma_f32_16x16x32_bf16 v[36:39], v[124:127], a[200:203], v[36:39]
    s_waitcnt lgkmcnt(5)
    v_mfma_f32_16x16x32_bf16 v[36:39], v[128:131], a[204:207], v[36:39]
    s_waitcnt lgkmcnt(2)
    v_mfma_f32_16x16x32_bf16 v[36:39], v[132:135], a[208:211], v[36:39]
    s_waitcnt lgkmcnt(1)
    v_mfma_f32_16x16x32_bf16 v[36:39], v[136:139], a[212:215], v[36:39]
    s_waitcnt vmcnt(11)
    v_lshlrev_b32 v228, 16, v96
    v_and_b32 v229, s39, v96
    v_lshlrev_b32 v230, 16, v97
    v_and_b32 v231, s39, v97
    v_lshlrev_b32 v232, 16, v98
    v_and_b32 v233, s39, v98
    v_lshlrev_b32 v234, 16, v99
    v_and_b32 v235, s39, v99
    v_pk_mul_f32 v[228:229], s[62:63], v[228:229]
    v_pk_mul_f32 v[230:231], s[62:63], v[230:231]
    v_pk_mul_f32 v[232:233], s[62:63], v[232:233]
    v_pk_mul_f32 v[234:235], s[62:63], v[234:235]
    v_cvt_pk_bf16_f32 v96, v228, v229
    v_cvt_pk_bf16_f32 v97, v230, v231
    v_cvt_pk_bf16_f32 v98, v232, v233
    v_cvt_pk_bf16_f32 v99, v234, v235
    ds_write_b128 v1, v[96:99] offset:1024
    ds_read_b128 a[216:219], v2
    ds_read_b128 a[220:223], v3
    buffer_load_dwordx4 v215, s[12:15], s24 offen offset:1024 lds
    s_waitcnt vmcnt(11)
    v_lshlrev_b32 v220, 16, v100
    v_and_b32 v221, s39, v100
    v_lshlrev_b32 v222, 16, v101
    v_and_b32 v223, s39, v101
    v_lshlrev_b32 v224, 16, v102
    v_and_b32 v225, s39, v102
    v_lshlrev_b32 v226, 16, v103
    v_and_b32 v227, s39, v103
    v_pk_mul_f32 v[220:221], s[62:63], v[220:221]
    v_pk_mul_f32 v[222:223], s[62:63], v[222:223]
    v_pk_mul_f32 v[224:225], s[62:63], v[224:225]
    v_pk_mul_f32 v[226:227], s[62:63], v[226:227]
    v_cvt_pk_bf16_f32 v100, v220, v221
    v_cvt_pk_bf16_f32 v101, v222, v223
    v_cvt_pk_bf16_f32 v102, v224, v225
    v_cvt_pk_bf16_f32 v103, v226, v227
    ds_write_b128 v1, v[100:103] offset:0
    buffer_load_dwordx4 v216, s[12:15], s24 offen offset:2048 lds
    v_max3_f32 v236, v36, v37, v38
    v_max_f32 v236, v236, v39
    v_mov_b32 v237, v236
    s_nop 0
    s_nop 0
    v_permlane32_swap_b32 v237, v236
    s_nop 0
    v_max_f32 v236, v237, v236
    v_mov_b32 v237, v236
    s_nop 0
    s_nop 0
    v_permlane16_swap_b32 v237, v236
    s_nop 0
    v_max_f32 v236, v237, v236
    v_sub_f32 v188, 0, v236
    v_sub_f32 v189, 0, v236
    v_sub_f32 v190, 0, v236
    v_sub_f32 v191, 0, v236
    s_waitcnt vmcnt(11)
    v_lshlrev_b32 v228, 16, v104
    v_and_b32 v229, s39, v104
    v_lshlrev_b32 v230, 16, v105
    v_and_b32 v231, s39, v105
    v_lshlrev_b32 v232, 16, v106
    v_and_b32 v233, s39, v106
    v_lshlrev_b32 v234, 16, v107
    v_and_b32 v235, s39, v107
    v_pk_mul_f32 v[228:229], s[62:63], v[228:229]
    v_pk_mul_f32 v[230:231], s[62:63], v[230:231]
    v_pk_mul_f32 v[232:233], s[62:63], v[232:233]
    v_pk_mul_f32 v[234:235], s[62:63], v[234:235]
    v_cvt_pk_bf16_f32 v104, v228, v229
    v_cvt_pk_bf16_f32 v105, v230, v231
    v_cvt_pk_bf16_f32 v106, v232, v233
    v_cvt_pk_bf16_f32 v107, v234, v235
    ds_write_b128 v1, v[104:107] offset:1024
    ds_read_b128 a[224:227], v2
    ds_read_b128 a[228:231], v3
    s_add_u32 m0, s28, 3072
    s_nop 0
    buffer_load_dwordx4 v214, s[12:15], s26 offen offset:0 lds
    s_waitcnt vmcnt(11)
    v_lshlrev_b32 v220, 16, v108
    v_and_b32 v221, s39, v108
    v_lshlrev_b32 v222, 16, v109
    v_and_b32 v223, s39, v109
    v_lshlrev_b32 v224, 16, v110
    v_and_b32 v225, s39, v110
    v_lshlrev_b32 v226, 16, v111
    v_and_b32 v227, s39, v111
    v_pk_mul_f32 v[220:221], s[62:63], v[220:221]
    v_pk_mul_f32 v[222:223], s[62:63], v[222:223]
    v_pk_mul_f32 v[224:225], s[62:63], v[224:225]
    v_pk_mul_f32 v[226:227], s[62:63], v[226:227]
    v_cvt_pk_bf16_f32 v108, v220, v221
    v_cvt_pk_bf16_f32 v109, v222, v223
    v_cvt_pk_bf16_f32 v110, v224, v225
    v_cvt_pk_bf16_f32 v111, v226, v227
    ds_write_b128 v1, v[108:111] offset:0
    buffer_load_dwordx4 v215, s[12:15], s26 offen offset:1024 lds
    s_waitcnt vmcnt(11)
    v_lshlrev_b32 v228, 16, v112
    v_and_b32 v229, s39, v112
    v_lshlrev_b32 v230, 16, v113
    v_and_b32 v231, s39, v113
    v_lshlrev_b32 v232, 16, v114
    v_and_b32 v233, s39, v114
    v_lshlrev_b32 v234, 16, v115
    v_and_b32 v235, s39, v115
    v_pk_mul_f32 v[228:229], s[62:63], v[228:229]
    v_pk_mul_f32 v[230:231], s[62:63], v[230:231]
    v_pk_mul_f32 v[232:233], s[62:63], v[232:233]
    v_pk_mul_f32 v[234:235], s[62:63], v[234:235]
    v_cvt_pk_bf16_f32 v112, v228, v229
    v_cvt_pk_bf16_f32 v113, v230, v231
    v_cvt_pk_bf16_f32 v114, v232, v233
    v_cvt_pk_bf16_f32 v115, v234, v235
    ds_write_b128 v1, v[112:115] offset:1024
    ds_read_b128 a[232:235], v2
    ds_read_b128 a[236:239], v3
    buffer_load_dwordx4 v216, s[12:15], s26 offen offset:2048 lds
    s_waitcnt lgkmcnt(9)
    v_mfma_f32_16x16x32_bf16 v[40:43], v[116:119], a[216:219], 0
    s_waitcnt lgkmcnt(8)
    v_mfma_f32_16x16x32_bf16 v[40:43], v[120:123], a[220:223], v[40:43]
    s_waitcnt lgkmcnt(5)
    v_mfma_f32_16x16x32_bf16 v[40:43], v[124:127], a[224:227], v[40:43]
    s_waitcnt lgkmcnt(4)
    v_mfma_f32_16x16x32_bf16 v[40:43], v[128:131], a[228:231], v[40:43]
    s_waitcnt lgkmcnt(1)
    v_mfma_f32_16x16x32_bf16 v[40:43], v[132:135], a[232:235], v[40:43]
    s_waitcnt lgkmcnt(0)
    v_mfma_f32_16x16x32_bf16 v[40:43], v[136:139], a[236:239], v[40:43]
    s_nop 1
    s_nop 1
    s_nop 1
    s_nop 1
    v_max3_f32 v236, v40, v41, v42
    v_max_f32 v236, v236, v43
    v_mov_b32 v237, v236
    s_nop 0
    s_nop 0
    v_permlane32_swap_b32 v237, v236
    s_nop 0
    v_max_f32 v236, v237, v236
    v_mov_b32 v237, v236
    s_nop 0
    s_nop 0
    v_permlane16_swap_b32 v237, v236
    s_nop 0
    v_max_f32 v236, v237, v236
    v_sub_f32 v192, 0, v236
    v_sub_f32 v193, 0, v236
    v_sub_f32 v194, 0, v236
    v_sub_f32 v195, 0, v236
L_main:
    s_mov_b32 s24, 0
    s_mov_b32 s26, 3072
    s_add_u32 s28, s60, 122880
    s_mov_b32 m0, s28
    v_mfma_f32_16x16x32_bf16 v[44:47], v[116:119], a[192:195], v[188:191]
    buffer_load_dwordx4 v214, s[48:51], s24 offen offset:0 lds
    v_mfma_f32_16x16x32_bf16 v[44:47], v[120:123], a[196:199], v[44:47]
    ds_read_b128 v[140:143], v208 offset:6144
    v_add_u32 v240, s60, v208
    v_mfma_f32_16x16x32_bf16 v[44:47], v[124:127], a[200:203], v[44:47]
    ds_read_b128 v[144:147], v209 offset:6144
    v_add_u32 v241, s60, v209
    v_mfma_f32_16x16x32_bf16 v[44:47], v[128:131], a[204:207], v[44:47]
    ds_read_b128 v[148:151], v208 offset:6272
    v_add_u32 v238, 122880, v240
    v_mfma_f32_16x16x32_bf16 v[44:47], v[132:135], a[208:211], v[44:47]
    buffer_load_dwordx4 v215, s[48:51], s24 offen offset:1024 lds
    v_mfma_f32_16x16x32_bf16 v[44:47], v[136:139], a[212:215], v[44:47]
    ds_read_b128 v[152:155], v209 offset:6272
    v_add_u32 v239, 122880, v241
    v_mfma_f32_16x16x32_bf16 v[48:51], v[116:119], a[216:219], v[192:195]
    ds_read_b128 v[156:159], v208 offset:6400
    v_mfma_f32_16x16x32_bf16 v[48:51], v[120:123], a[220:223], v[48:51]
    ds_read_b128 v[160:163], v209 offset:6400
    v_mfma_f32_16x16x32_bf16 v[48:51], v[124:127], a[224:227], v[48:51]
    buffer_load_dwordx4 v216, s[48:51], s24 offen offset:2048 lds
    s_add_u32 m0, s28, 3072
    v_mfma_f32_16x16x32_bf16 v[48:51], v[128:131], a[228:231], v[48:51]
    v_exp_f32 v44, v44
    v_mfma_f32_16x16x32_bf16 v[48:51], v[132:135], a[232:235], v[48:51]
    v_exp_f32 v45, v45
    v_mfma_f32_16x16x32_bf16 v[48:51], v[136:139], a[236:239], v[48:51]
    s_waitcnt lgkmcnt(5)
    ds_read_b128 v[116:119], v208 offset:12288
    v_cvt_pk_bf16_f32 v84, v44, v45
    v_mfma_f32_16x16x32_bf16 v[36:39], v[140:143], a[192:195], v[188:191]
    s_waitcnt lgkmcnt(5)
    buffer_load_dwordx4 v214, s[48:51], s26 offen offset:0 lds
    v_mfma_f32_16x16x32_bf16 v[36:39], v[144:147], a[196:199], v[36:39]
    s_waitcnt lgkmcnt(4)
    v_exp_f32 v46, v46
    v_mfma_f32_16x16x32_bf16 v[36:39], v[148:151], a[200:203], v[36:39]
    s_waitcnt lgkmcnt(3)
    v_exp_f32 v47, v47
    v_mfma_f32_16x16x32_bf16 v[36:39], v[152:155], a[204:207], v[36:39]
    s_waitcnt lgkmcnt(2)
    ds_read_b128 v[120:123], v209 offset:12288
    v_cvt_pk_bf16_f32 v85, v46, v47
    v_mfma_f32_16x16x32_bf16 v[36:39], v[156:159], a[208:211], v[36:39]
    s_waitcnt lgkmcnt(2)
    buffer_load_dwordx4 v215, s[48:51], s26 offen offset:1024 lds
    v_mfma_f32_16x16x32_bf16 v[36:39], v[160:163], a[212:215], v[36:39]
    v_exp_f32 v48, v48
    v_mfma_f32_16x16x32_bf16 v[40:43], v[140:143], a[216:219], v[192:195]
    v_exp_f32 v49, v49
    v_mfma_f32_16x16x32_bf16 v[40:43], v[144:147], a[220:223], v[40:43]
    ds_read_b128 v[124:127], v208 offset:12416
    v_cvt_pk_bf16_f32 v92, v48, v49
    v_mfma_f32_16x16x32_bf16 v[40:43], v[148:151], a[224:227], v[40:43]
    ds_read_b128 v[128:131], v209 offset:12416
    v_exp_f32 v50, v50
    v_mfma_f32_16x16x32_bf16 v[40:43], v[152:155], a[228:231], v[40:43]
    ds_read_b128 v[132:135], v208 offset:12544
    v_exp_f32 v51, v51
    v_mfma_f32_16x16x32_bf16 v[40:43], v[156:159], a[232:235], v[40:43]
    ds_read_b128 v[136:139], v209 offset:12544
    buffer_load_dwordx4 v216, s[48:51], s26 offen offset:2048 lds
    s_mov_b32 s24, 0
    s_mov_b32 s26, 3072
    s_add_u32 s28, s60, 49152
    s_mov_b32 m0, s28
    v_mfma_f32_16x16x32_bf16 v[40:43], v[160:163], a[236:239], v[40:43]
    s_waitcnt lgkmcnt(5)
    ds_read_b128 v[140:143], v208 offset:18432
    v_cvt_pk_bf16_f32 v93, v50, v51
    v_mfma_f32_16x16x32_bf16 v[44:47], v[116:119], a[192:195], v[188:191]
    s_waitcnt lgkmcnt(5)
    v_exp_f32 v36, v36
    v_mfma_f32_16x16x32_bf16 v[44:47], v[120:123], a[196:199], v[44:47]
    s_waitcnt lgkmcnt(4)
    v_exp_f32 v37, v37
    v_mfma_f32_16x16x32_bf16 v[44:47], v[124:127], a[200:203], v[44:47]
    s_waitcnt lgkmcnt(3)
    buffer_load_dwordx4 v214, s[12:15], s24 offen offset:0 lds
    v_mfma_f32_16x16x32_bf16 v[44:47], v[128:131], a[204:207], v[44:47]
    s_waitcnt lgkmcnt(2)
    ds_read_b128 v[144:147], v209 offset:18432
    v_cvt_pk_bf16_f32 v86, v36, v37
    v_mfma_f32_16x16x32_bf16 v[44:47], v[132:135], a[208:211], v[44:47]
    s_waitcnt lgkmcnt(2)
    v_exp_f32 v38, v38
    v_mfma_f32_16x16x32_bf16 v[44:47], v[136:139], a[212:215], v[44:47]
    v_exp_f32 v39, v39
    v_mfma_f32_16x16x32_bf16 v[48:51], v[116:119], a[216:219], v[192:195]
    buffer_load_dwordx4 v215, s[12:15], s24 offen offset:1024 lds
    v_mfma_f32_16x16x32_bf16 v[48:51], v[120:123], a[220:223], v[48:51]
    ds_read_b128 v[148:151], v208 offset:18560
    v_cvt_pk_bf16_f32 v87, v38, v39
    v_mfma_f32_16x16x32_bf16 v[48:51], v[124:127], a[224:227], v[48:51]
    ds_read_b128 v[152:155], v209 offset:18560
    v_exp_f32 v40, v40
    v_mfma_f32_16x16x32_bf16 v[48:51], v[128:131], a[228:231], v[48:51]
    ds_read_b128 v[156:159], v208 offset:18688
    v_add_u32 v208, 24576, v208
    v_mfma_f32_16x16x32_bf16 v[48:51], v[132:135], a[232:235], v[48:51]
    ds_read_b128 v[160:163], v209 offset:18688
    v_add_u32 v209, 24576, v209
    v_mfma_f32_16x16x32_bf16 v[48:51], v[136:139], a[236:239], v[48:51]
    s_waitcnt lgkmcnt(5)
    buffer_load_dwordx4 v216, s[12:15], s24 offen offset:2048 lds
    s_add_u32 m0, s28, 3072
    v_exp_f32 v41, v41
    v_mfma_f32_16x16x32_bf16 v[36:39], v[140:143], a[192:195], v[188:191]
    s_waitcnt lgkmcnt(4)
    buffer_load_dwordx4 v214, s[12:15], s26 offen offset:0 lds
    v_exp_f32 v42, v42
    v_mfma_f32_16x16x32_bf16 v[36:39], v[144:147], a[196:199], v[36:39]
    s_waitcnt lgkmcnt(3)
    buffer_load_dwordx4 v215, s[12:15], s26 offen offset:1024 lds
    v_exp_f32 v43, v43
    v_mfma_f32_16x16x32_bf16 v[36:39], v[148:151], a[200:203], v[36:39]
    buffer_load_dwordx4 v216, s[12:15], s26 offen offset:2048 lds
    s_waitcnt vmcnt(12) lgkmcnt(0)
    s_barrier
    s_mov_b32 s25, 761856
    s_mov_b32 s27, 764928
    s_add_u32 s29, s60, 98304
    s_mov_b32 m0, s29
    v_exp_f32 v44, v44
    ds_read_b128 v[116:119], v208 offset:0
    v_mfma_f32_16x16x32_bf16 v[36:39], v[152:155], a[204:207], v[36:39]
    ds_read_b128 v[120:123], v209 offset:0
    v_exp_f32 v45, v45
    v_mfma_f32_16x16x32_bf16 v[36:39], v[156:159], a[208:211], v[36:39]
    ds_read_b128 v[124:127], v208 offset:128
    v_cvt_pk_bf16_f32 v94, v40, v41
    v_cvt_pk_bf16_f32 v95, v42, v43
    v_exp_f32 v46, v46
    v_mfma_f32_16x16x32_bf16 v[36:39], v[160:163], a[212:215], v[36:39]
    ds_read_b64_tr_b16 v[164:165], v210 offset:0
    v_exp_f32 v47, v47
    v_mfma_f32_16x16x32_bf16 v[40:43], v[140:143], a[216:219], v[192:195]
    ds_read_b64_tr_b16 v[166:167], v210 offset:6144
    v_exp_f32 v48, v48
    v_mfma_f32_16x16x32_bf16 v[40:43], v[144:147], a[220:223], v[40:43]
    ds_read_b64_tr_b16 v[168:169], v210 offset:12288
    v_exp_f32 v49, v49
    v_mfma_f32_16x16x32_bf16 v[40:43], v[148:151], a[224:227], v[40:43]
    ds_read_b128 v[128:131], v209 offset:128
    v_exp_f32 v50, v50
    buffer_load_dwordx4 v214, s[16:19], s25 offen offset:0 lds
    v_mfma_f32_16x16x32_bf16 v[40:43], v[152:155], a[228:231], v[40:43]
    ds_read_b128 v[132:135], v208 offset:256
    v_exp_f32 v51, v51
    v_mfma_f32_16x16x32_bf16 v[40:43], v[156:159], a[232:235], v[40:43]
    ds_read_b128 v[136:139], v209 offset:256
    v_cvt_pk_bf16_f32 v88, v44, v45
    v_cvt_pk_bf16_f32 v89, v46, v47
    v_exp_f32 v36, v36
    v_mfma_f32_16x16x32_bf16 v[40:43], v[160:163], a[236:239], v[40:43]
    s_waitcnt lgkmcnt(8)
    v_exp_f32 v37, v37
    v_mfma_f32_16x16x32_bf16 v[44:47], v[116:119], a[192:195], v[188:191]
    s_waitcnt lgkmcnt(7)
    ds_read_b64_tr_b16 v[170:171], v210 offset:18432
    v_exp_f32 v38, v38
    v_mfma_f32_16x16x32_bf16 v[44:47], v[120:123], a[196:199], v[44:47]
    s_waitcnt lgkmcnt(7)
    ds_read_b64_tr_b16 v[172:173], v211 offset:0
    v_exp_f32 v39, v39
    v_mfma_f32_16x16x32_bf16 v[44:47], v[124:127], a[200:203], v[44:47]
    s_waitcnt lgkmcnt(4)
    ds_read_b64_tr_b16 v[174:175], v211 offset:6144
    v_exp_f32 v40, v40
    buffer_load_dwordx4 v215, s[16:19], s25 offen offset:1024 lds
    v_mfma_f32_16x16x32_bf16 v[44:47], v[128:131], a[204:207], v[44:47]
    s_waitcnt lgkmcnt(4)
    ds_read_b64_tr_b16 v[176:177], v211 offset:12288
    v_exp_f32 v41, v41
    v_mfma_f32_16x16x32_bf16 v[44:47], v[132:135], a[208:211], v[44:47]
    s_waitcnt lgkmcnt(4)
    ds_read_b64_tr_b16 v[178:179], v211 offset:18432
    v_exp_f32 v42, v42
    v_mfma_f32_16x16x32_bf16 v[44:47], v[136:139], a[212:215], v[44:47]
    v_cvt_pk_bf16_f32 v90, v36, v37
    v_cvt_pk_bf16_f32 v91, v38, v39
    v_exp_f32 v43, v43
    v_mfma_f32_16x16x32_bf16 a[0:3], v[84:87], v[164:167], a[0:3]
    s_waitcnt lgkmcnt(4)
    v_cvt_pk_bf16_f32 v96, v48, v49
    v_cvt_pk_bf16_f32 v97, v50, v51
    v_cvt_pk_bf16_f32 v98, v40, v41
    v_cvt_pk_bf16_f32 v99, v42, v43
    v_mfma_f32_16x16x32_bf16 a[0:3], v[88:91], v[168:171], a[0:3]
    buffer_load_dwordx4 v216, s[16:19], s25 offen offset:2048 lds
    s_add_u32 m0, s29, 3072
    v_mfma_f32_16x16x32_bf16 a[4:7], v[96:99], v[168:171], a[4:7]
    v_exp_f32 v44, v44
    v_mfma_f32_16x16x32_bf16 a[4:7], v[92:95], v[164:167], a[4:7]
    s_waitcnt lgkmcnt(2)
    v_exp_f32 v45, v45
    v_mfma_f32_16x16x32_bf16 a[16:19], v[84:87], v[172:175], a[16:19]
    s_waitcnt lgkmcnt(0)
    ds_read_b64_tr_b16 v[180:181], v212 offset:0
    v_cvt_pk_bf16_f32 v52, v44, v45
    v_mfma_f32_16x16x32_bf16 a[16:19], v[88:91], v[176:179], a[16:19]
    buffer_load_dwordx4 v214, s[16:19], s27 offen offset:0 lds
    v_mfma_f32_16x16x32_bf16 v[48:51], v[116:119], a[216:219], v[192:195]
    ds_read_b64_tr_b16 v[182:183], v212 offset:6144
    v_exp_f32 v46, v46
    v_mfma_f32_16x16x32_bf16 v[48:51], v[120:123], a[220:223], v[48:51]
    ds_read_b64_tr_b16 v[184:185], v212 offset:12288
    v_exp_f32 v47, v47
    v_mfma_f32_16x16x32_bf16 v[48:51], v[124:127], a[224:227], v[48:51]
    ds_read_b64_tr_b16 v[186:187], v212 offset:18432
    v_cvt_pk_bf16_f32 v53, v46, v47
    v_mfma_f32_16x16x32_bf16 v[48:51], v[128:131], a[228:231], v[48:51]
    ds_read_b128 v[140:143], v208 offset:6144
    v_mfma_f32_16x16x32_bf16 v[48:51], v[132:135], a[232:235], v[48:51]
    ds_read_b128 v[144:147], v209 offset:6144
    v_mfma_f32_16x16x32_bf16 v[48:51], v[136:139], a[236:239], v[48:51]
    ds_read_b128 v[148:151], v208 offset:6272
    buffer_load_dwordx4 v215, s[16:19], s27 offen offset:1024 lds
    v_mfma_f32_16x16x32_bf16 a[20:23], v[96:99], v[176:179], a[20:23]
    ds_read_b128 v[152:155], v209 offset:6272
    v_mfma_f32_16x16x32_bf16 a[20:23], v[92:95], v[172:175], a[20:23]
    s_waitcnt lgkmcnt(6)
    ds_read_b128 v[156:159], v208 offset:6400
    v_mfma_f32_16x16x32_bf16 a[32:35], v[84:87], v[180:183], a[32:35]
    s_waitcnt lgkmcnt(5)
    ds_read_b128 v[160:163], v209 offset:6400
    v_exp_f32 v48, v48
    v_mfma_f32_16x16x32_bf16 a[32:35], v[88:91], v[184:187], a[32:35]
    ds_read_b64_tr_b16 v[164:165], v213 offset:0
    v_exp_f32 v49, v49
    v_mfma_f32_16x16x32_bf16 a[36:39], v[96:99], v[184:187], a[36:39]
    ds_read_b64_tr_b16 v[166:167], v213 offset:6144
    v_cvt_pk_bf16_f32 v60, v48, v49
    v_mfma_f32_16x16x32_bf16 a[36:39], v[92:95], v[180:183], a[36:39]
    s_waitcnt lgkmcnt(7)
    ds_read_b64_tr_b16 v[168:169], v213 offset:12288
    buffer_load_dwordx4 v216, s[16:19], s27 offen offset:2048 lds
    s_mov_b32 s24, 6144
    s_mov_b32 s26, 9216
    s_add_u32 s28, s60, 0
    s_mov_b32 m0, s28
    v_mfma_f32_16x16x32_bf16 v[36:39], v[140:143], a[192:195], v[188:191]
    s_waitcnt lgkmcnt(7)
    ds_read_b64_tr_b16 v[170:171], v213 offset:18432
    v_exp_f32 v50, v50
    v_mfma_f32_16x16x32_bf16 v[36:39], v[144:147], a[196:199], v[36:39]
    s_waitcnt lgkmcnt(7)
    ds_read_b64_tr_b16 v[172:173], v210 offset:128
    v_exp_f32 v51, v51
    v_mfma_f32_16x16x32_bf16 v[36:39], v[148:151], a[200:203], v[36:39]
    s_waitcnt lgkmcnt(7)
    ds_read_b64_tr_b16 v[174:175], v210 offset:6272
    v_cvt_pk_bf16_f32 v61, v50, v51
    v_mfma_f32_16x16x32_bf16 v[36:39], v[152:155], a[204:207], v[36:39]
    s_waitcnt lgkmcnt(7)
    ds_read_b64_tr_b16 v[176:177], v210 offset:12416
    v_mfma_f32_16x16x32_bf16 v[36:39], v[156:159], a[208:211], v[36:39]
    s_waitcnt lgkmcnt(7)
    s_waitcnt vmcnt(12)
    ds_read_b64_tr_b16 v[178:179], v210 offset:18560
    ds_read_b128 v[68:71], v238 offset:0
    v_mfma_f32_16x16x32_bf16 v[36:39], v[160:163], a[212:215], v[36:39]
    s_waitcnt lgkmcnt(7)
    ds_read_b128 v[72:75], v239 offset:0
    buffer_load_dwordx4 v214, s[48:51], s24 offen offset:0 lds
    v_mfma_f32_16x16x32_bf16 a[48:51], v[84:87], v[164:167], a[48:51]
    s_waitcnt lgkmcnt(6)
    ds_read_b128 v[76:79], v238 offset:128
    v_mfma_f32_16x16x32_bf16 a[48:51], v[88:91], v[168:171], a[48:51]
    ds_read_b128 v[80:83], v239 offset:128
    v_mfma_f32_16x16x32_bf16 a[52:55], v[96:99], v[168:171], a[52:55]
    ds_read_b128 v[4:7], v238 offset:256
    v_exp_f32 v36, v36
    v_mfma_f32_16x16x32_bf16 a[52:55], v[92:95], v[164:167], a[52:55]
    s_waitcnt lgkmcnt(7)
    ds_read_b128 v[8:11], v239 offset:256
    v_exp_f32 v37, v37
    v_mfma_f32_16x16x32_bf16 a[64:67], v[84:87], v[172:175], a[64:67]
    s_waitcnt lgkmcnt(6)
    buffer_load_dwordx4 v215, s[48:51], s24 offen offset:1024 lds
    v_mfma_f32_16x16x32_bf16 a[64:67], v[88:91], v[176:179], a[64:67]
    s_waitcnt lgkmcnt(5)
    ds_read_b64_tr_b16 v[180:181], v211 offset:128
    v_lshlrev_b32 v220, 16, v68
    v_and_b32 v221, s39, v68
    v_lshlrev_b32 v222, 16, v69
    v_mfma_f32_16x16x32_bf16 v[40:43], v[140:143], a[216:219], v[192:195]
    ds_read_b64_tr_b16 v[182:183], v211 offset:6272
    v_and_b32 v223, s39, v69
    v_lshlrev_b32 v224, 16, v70
    v_mfma_f32_16x16x32_bf16 v[40:43], v[144:147], a[220:223], v[40:43]
    ds_read_b64_tr_b16 v[184:185], v211 offset:12416
    v_and_b32 v225, s39, v70
    v_lshlrev_b32 v226, 16, v71
    v_and_b32 v227, s39, v71
    v_mfma_f32_16x16x32_bf16 v[40:43], v[148:151], a[224:227], v[40:43]
    ds_read_b64_tr_b16 v[186:187], v211 offset:18560
    v_mul_f32 v220, s62, v220
    v_mul_f32 v221, s62, v221
    v_mfma_f32_16x16x32_bf16 v[40:43], v[152:155], a[228:231], v[40:43]
    v_mul_f32 v222, s62, v222
    v_mul_f32 v223, s62, v223
    v_mul_f32 v224, s62, v224
    v_mfma_f32_16x16x32_bf16 v[40:43], v[156:159], a[232:235], v[40:43]
    buffer_load_dwordx4 v216, s[48:51], s24 offen offset:2048 lds
    s_add_u32 m0, s28, 3072
    v_mul_f32 v225, s62, v225
    v_mul_f32 v226, s62, v226
    v_mfma_f32_16x16x32_bf16 v[40:43], v[160:163], a[236:239], v[40:43]
    ds_read_b128 v[116:119], v208 offset:12288
    v_mul_f32 v227, s62, v227
    v_cvt_pk_bf16_f32 v68, v220, v221
    v_cvt_pk_bf16_f32 v69, v222, v223
    v_mfma_f32_16x16x32_bf16 a[68:71], v[96:99], v[176:179], a[68:71]
    ds_read_b128 v[120:123], v209 offset:12288
    v_cvt_pk_bf16_f32 v70, v224, v225
    v_cvt_pk_bf16_f32 v71, v226, v227
    v_mfma_f32_16x16x32_bf16 a[68:71], v[92:95], v[172:175], a[68:71]
    s_waitcnt lgkmcnt(4)
    ds_read_b128 v[124:127], v208 offset:12416
    v_accvgpr_write_b32 a240, v68
    v_accvgpr_write_b32 a241, v69
    v_accvgpr_write_b32 a242, v70
    v_mfma_f32_16x16x32_bf16 a[80:83], v[84:87], v[180:183], a[80:83]
    s_waitcnt lgkmcnt(3)
    ds_read_b128 v[128:131], v209 offset:12416
    v_accvgpr_write_b32 a243, v71
    v_lshlrev_b32 v228, 16, v72
    v_mfma_f32_16x16x32_bf16 a[80:83], v[88:91], v[184:187], a[80:83]
    ds_read_b128 v[132:135], v208 offset:12544
    v_and_b32 v229, s39, v72
    v_lshlrev_b32 v230, 16, v73
    v_and_b32 v231, s39, v73
    v_mfma_f32_16x16x32_bf16 a[84:87], v[96:99], v[184:187], a[84:87]
    ds_read_b128 v[136:139], v209 offset:12544
    buffer_load_dwordx4 v214, s[48:51], s26 offen offset:0 lds
    v_lshlrev_b32 v232, 16, v74
    v_and_b32 v233, s39, v74
    v_mfma_f32_16x16x32_bf16 a[84:87], v[92:95], v[180:183], a[84:87]
    s_waitcnt lgkmcnt(5)
    ds_read_b64_tr_b16 v[164:165], v212 offset:128
    v_lshlrev_b32 v234, 16, v75
    v_and_b32 v235, s39, v75
    v_mul_f32 v228, s62, v228
    v_mfma_f32_16x16x32_bf16 v[44:47], v[116:119], a[192:195], v[188:191]
    s_waitcnt lgkmcnt(5)
    ds_read_b64_tr_b16 v[166:167], v212 offset:6272
    v_mul_f32 v229, s62, v229
    v_mul_f32 v230, s62, v230
    v_mfma_f32_16x16x32_bf16 v[44:47], v[120:123], a[196:199], v[44:47]
    s_waitcnt lgkmcnt(5)
    ds_read_b64_tr_b16 v[168:169], v212 offset:12416
    v_mul_f32 v231, s62, v231
    v_mul_f32 v232, s62, v232
    v_mul_f32 v233, s62, v233
    v_mfma_f32_16x16x32_bf16 v[44:47], v[124:127], a[200:203], v[44:47]
    s_waitcnt lgkmcnt(5)
    ds_read_b64_tr_b16 v[170:171], v212 offset:18560
    v_mul_f32 v234, s62, v234
    v_mul_f32 v235, s62, v235
    v_mfma_f32_16x16x32_bf16 v[44:47], v[128:131], a[204:207], v[44:47]
    s_waitcnt lgkmcnt(5)
    ds_read_b64_tr_b16 v[172:173], v213 offset:128
    v_cvt_pk_bf16_f32 v72, v228, v229
    v_cvt_pk_bf16_f32 v73, v230, v231
    v_cvt_pk_bf16_f32 v74, v232, v233
    v_mfma_f32_16x16x32_bf16 v[44:47], v[132:135], a[208:211], v[44:47]
    s_waitcnt lgkmcnt(5)
    ds_read_b64_tr_b16 v[174:175], v213 offset:6272
    buffer_load_dwordx4 v215, s[48:51], s26 offen offset:1024 lds
    v_cvt_pk_bf16_f32 v75, v234, v235
    v_accvgpr_write_b32 a244, v72
    v_mfma_f32_16x16x32_bf16 v[44:47], v[136:139], a[212:215], v[44:47]
    ds_read_b64_tr_b16 v[176:177], v213 offset:12416
    v_accvgpr_write_b32 a245, v73
    v_accvgpr_write_b32 a246, v74
    v_accvgpr_write_b32 a247, v75
    v_smfmac_f32_16x16x64_bf16 v[204:207], v[244:247], v[84:91], v218
    ds_read_b64_tr_b16 v[178:179], v213 offset:18560
    v_lshlrev_b32 v220, 16, v76
    v_and_b32 v221, s39, v76
    v_smfmac_f32_16x16x64_bf16 v[204:207], v[248:251], v[92:99], v218
    s_waitcnt lgkmcnt(6)
    v_lshlrev_b32 v222, 16, v77
    v_and_b32 v223, s39, v77
    v_lshlrev_b32 v224, 16, v78
    v_mfma_f32_16x16x32_bf16 a[96:99], v[84:87], v[164:167], a[96:99]
    s_waitcnt lgkmcnt(4)
    v_and_b32 v225, s39, v78
    v_lshlrev_b32 v226, 16, v79
    v_mfma_f32_16x16x32_bf16 a[96:99], v[88:91], v[168:171], a[96:99]
    v_and_b32 v227, s39, v79
    v_mul_f32 v220, s62, v220
    v_mul_f32 v221, s62, v221
    v_mfma_f32_16x16x32_bf16 a[100:103], v[96:99], v[168:171], a[100:103]
    buffer_load_dwordx4 v216, s[48:51], s26 offen offset:2048 lds
    s_mov_b32 s25, 0
    s_mov_b32 s27, 3072
    s_add_u32 s29, s60, 122880
    s_mov_b32 m0, s29
    v_mul_f32 v222, s62, v222
    v_mul_f32 v223, s62, v223
    v_mfma_f32_16x16x32_bf16 a[100:103], v[92:95], v[164:167], a[100:103]
    s_waitcnt lgkmcnt(2)
    v_mul_f32 v224, s62, v224
    v_mul_f32 v225, s62, v225
    v_mul_f32 v226, s62, v226
    v_mfma_f32_16x16x32_bf16 a[112:115], v[84:87], v[172:175], a[112:115]
    s_waitcnt lgkmcnt(0)
    v_mul_f32 v227, s62, v227
    v_cvt_pk_bf16_f32 v76, v220, v221
    v_mfma_f32_16x16x32_bf16 a[112:115], v[88:91], v[176:179], a[112:115]
    ds_read_b64_tr_b16 v[180:181], v210 offset:256
    v_cvt_pk_bf16_f32 v77, v222, v223
    v_cvt_pk_bf16_f32 v78, v224, v225
    v_cvt_pk_bf16_f32 v79, v226, v227
    v_mfma_f32_16x16x32_bf16 v[48:51], v[116:119], a[216:219], v[192:195]
    ds_read_b64_tr_b16 v[182:183], v210 offset:6400
    v_accvgpr_write_b32 a248, v76
    v_accvgpr_write_b32 a249, v77
    v_mfma_f32_16x16x32_bf16 v[48:51], v[120:123], a[220:223], v[48:51]
    ds_read_b64_tr_b16 v[184:185], v210 offset:12544
    v_accvgpr_write_b32 a250, v78
    v_accvgpr_write_b32 a251, v79
    v_lshlrev_b32 v228, 16, v80
    v_mfma_f32_16x16x32_bf16 v[48:51], v[124:127], a[224:227], v[48:51]
    ds_read_b64_tr_b16 v[186:187], v210 offset:18688
    buffer_load_dwordx4 v214, s[16:19], s25 offen offset:0 lds
    v_and_b32 v229, s39, v80
    v_lshlrev_b32 v230, 16, v81
    v_mfma_f32_16x16x32_bf16 v[48:51], v[128:131], a[228:231], v[48:51]
    ds_read_b128 v[140:143], v208 offset:18432
    v_and_b32 v231, s39, v81
    v_lshlrev_b32 v232, 16, v82
    v_and_b32 v233, s39, v82
    v_mfma_f32_16x16x32_bf16 v[48:51], v[132:135], a[232:235], v[48:51]
    ds_read_b128 v[144:147], v209 offset:18432
    v_lshlrev_b32 v234, 16, v83
    v_and_b32 v235, s39, v83
    v_mfma_f32_16x16x32_bf16 v[48:51], v[136:139], a[236:239], v[48:51]
    ds_read_b128 v[148:151], v208 offset:18560
    v_mul_f32 v228, s62, v228
    v_mul_f32 v229, s62, v229
    v_mul_f32 v230, s62, v230
    v_mfma_f32_16x16x32_bf16 a[116:119], v[96:99], v[176:179], a[116:119]
    ds_read_b128 v[152:155], v209 offset:18560
    v_mul_f32 v231, s62, v231
    v_mul_f32 v232, s62, v232
    v_mfma_f32_16x16x32_bf16 a[116:119], v[92:95], v[172:175], a[116:119]
    s_waitcnt lgkmcnt(6)
    ds_read_b128 v[156:159], v208 offset:18688
    v_mul_f32 v233, s62, v233
    v_mul_f32 v234, s62, v234
    v_mul_f32 v235, s62, v235
    v_mfma_f32_16x16x32_bf16 a[128:131], v[84:87], v[180:183], a[128:131]
    s_waitcnt lgkmcnt(5)
    ds_read_b128 v[160:163], v209 offset:18688
    v_exp_f32 v38, v38
    buffer_load_dwordx4 v215, s[16:19], s25 offen offset:1024 lds
    v_cvt_pk_bf16_f32 v80, v228, v229
    v_cvt_pk_bf16_f32 v81, v230, v231
    v_mfma_f32_16x16x32_bf16 a[128:131], v[88:91], v[184:187], a[128:131]
    ds_read_b64_tr_b16 v[164:165], v211 offset:256
    v_exp_f32 v39, v39
    v_cvt_pk_bf16_f32 v82, v232, v233
    v_cvt_pk_bf16_f32 v83, v234, v235
    v_accvgpr_write_b32 a252, v80
    v_mfma_f32_16x16x32_bf16 a[132:135], v[96:99], v[184:187], a[132:135]
    ds_read_b64_tr_b16 v[166:167], v211 offset:6400
    v_cvt_pk_bf16_f32 v54, v36, v37
    v_cvt_pk_bf16_f32 v55, v38, v39
    v_accvgpr_write_b32 a253, v81
    v_accvgpr_write_b32 a254, v82
    v_mfma_f32_16x16x32_bf16 a[132:135], v[92:95], v[180:183], a[132:135]
    s_waitcnt lgkmcnt(7)
    ds_read_b64_tr_b16 v[168:169], v211 offset:12544
    v_accvgpr_write_b32 a255, v83
    v_lshlrev_b32 v220, 16, v4
    v_and_b32 v221, s39, v4
    v_mfma_f32_16x16x32_bf16 v[36:39], v[140:143], a[192:195], v[188:191]
    s_waitcnt lgkmcnt(7)
    ds_read_b64_tr_b16 v[170:171], v211 offset:18688
    v_lshlrev_b32 v222, 16, v5
    v_and_b32 v223, s39, v5
    v_mfma_f32_16x16x32_bf16 v[36:39], v[144:147], a[196:199], v[36:39]
    s_waitcnt lgkmcnt(7)
    ds_read_b64_tr_b16 v[172:173], v212 offset:256
    v_lshlrev_b32 v224, 16, v6
    v_and_b32 v225, s39, v6
    v_lshlrev_b32 v226, 16, v7
    v_mfma_f32_16x16x32_bf16 v[36:39], v[148:151], a[200:203], v[36:39]
    s_waitcnt lgkmcnt(7)
    ds_read_b64_tr_b16 v[174:175], v212 offset:6400
    buffer_load_dwordx4 v216, s[16:19], s25 offen offset:2048 lds
    s_add_u32 m0, s29, 3072
    v_and_b32 v227, s39, v7
    v_mul_f32 v220, s62, v220
    v_mfma_f32_16x16x32_bf16 v[36:39], v[152:155], a[204:207], v[36:39]
    s_waitcnt lgkmcnt(7)
    ds_read_b64_tr_b16 v[176:177], v212 offset:12544
    v_mul_f32 v221, s62, v221
    v_mul_f32 v222, s62, v222
    v_mul_f32 v223, s62, v223
    v_mfma_f32_16x16x32_bf16 v[36:39], v[156:159], a[208:211], v[36:39]
    s_waitcnt lgkmcnt(7)
    ds_read_b64_tr_b16 v[178:179], v212 offset:18688
    v_mul_f32 v224, s62, v224
    v_mul_f32 v225, s62, v225
    v_mfma_f32_16x16x32_bf16 v[36:39], v[160:163], a[212:215], v[36:39]
    s_waitcnt lgkmcnt(6)
    v_mul_f32 v226, s62, v226
    v_mul_f32 v227, s62, v227
    v_cvt_pk_bf16_f32 v4, v220, v221
    v_mfma_f32_16x16x32_bf16 a[144:147], v[84:87], v[164:167], a[144:147]
    s_waitcnt lgkmcnt(4)
    v_exp_f32 v40, v40
    v_cvt_pk_bf16_f32 v5, v222, v223
    v_cvt_pk_bf16_f32 v6, v224, v225
    v_mfma_f32_16x16x32_bf16 a[144:147], v[88:91], v[168:171], a[144:147]
    v_exp_f32 v41, v41
    v_cvt_pk_bf16_f32 v7, v226, v227
    v_lshlrev_b32 v228, 16, v8
    v_and_b32 v229, s39, v8
    v_mfma_f32_16x16x32_bf16 a[148:151], v[96:99], v[168:171], a[148:151]
    v_exp_f32 v42, v42
    buffer_load_dwordx4 v214, s[16:19], s27 offen offset:0 lds
    v_lshlrev_b32 v230, 16, v9
    v_and_b32 v231, s39, v9
    v_mfma_f32_16x16x32_bf16 a[148:151], v[92:95], v[164:167], a[148:151]
    s_waitcnt lgkmcnt(2)
    v_exp_f32 v43, v43
    v_lshlrev_b32 v232, 16, v10
    v_and_b32 v233, s39, v10
    v_lshlrev_b32 v234, 16, v11
    v_mfma_f32_16x16x32_bf16 a[160:163], v[84:87], v[172:175], a[160:163]
    s_waitcnt lgkmcnt(0)
    v_cvt_pk_bf16_f32 v62, v40, v41
    v_cvt_pk_bf16_f32 v63, v42, v43
    v_and_b32 v235, s39, v11
    v_mul_f32 v228, s62, v228
    v_mfma_f32_16x16x32_bf16 a[160:163], v[88:91], v[176:179], a[160:163]
    v_mul_f32 v229, s62, v229
    v_mul_f32 v230, s62, v230
    v_mul_f32 v231, s62, v231
    v_mfma_f32_16x16x32_bf16 v[40:43], v[140:143], a[216:219], v[192:195]
    v_mul_f32 v232, s62, v232
    v_mul_f32 v233, s62, v233
    v_mfma_f32_16x16x32_bf16 v[40:43], v[144:147], a[220:223], v[40:43]
    ds_read_b64_tr_b16 v[180:181], v213 offset:256
    v_mul_f32 v234, s62, v234
    v_mul_f32 v235, s62, v235
    v_cvt_pk_bf16_f32 v8, v228, v229
    v_mfma_f32_16x16x32_bf16 v[40:43], v[148:151], a[224:227], v[40:43]
    ds_read_b64_tr_b16 v[182:183], v213 offset:6400
    buffer_load_dwordx4 v215, s[16:19], s27 offen offset:1024 lds
    v_cvt_pk_bf16_f32 v9, v230, v231
    v_cvt_pk_bf16_f32 v10, v232, v233
    v_mfma_f32_16x16x32_bf16 v[40:43], v[152:155], a[228:231], v[40:43]
    ds_read_b64_tr_b16 v[184:185], v213 offset:12544
    v_cvt_pk_bf16_f32 v11, v234, v235
    v_mfma_f32_16x16x32_bf16 v[40:43], v[156:159], a[232:235], v[40:43]
    ds_read_b64_tr_b16 v[186:187], v213 offset:18688
    v_add_u32 v208, 24576, v208
    v_mfma_f32_16x16x32_bf16 v[40:43], v[160:163], a[236:239], v[40:43]
    v_exp_f32 v44, v44
    v_mfma_f32_16x16x32_bf16 v[100:103], v[140:143], a[240:243], 0
    buffer_load_dwordx4 v216, s[16:19], s27 offen offset:2048 lds
    s_mov_b32 s24, 24576
    s_mov_b32 s26, 27648
    s_add_u32 s28, s60, 0
    s_mov_b32 m0, s28
    v_mfma_f32_16x16x32_bf16 v[100:103], v[144:147], a[244:247], v[100:103]
    v_exp_f32 v45, v45
    v_mfma_f32_16x16x32_bf16 v[100:103], v[148:151], a[248:251], v[100:103]
    s_waitcnt vmcnt(12) lgkmcnt(0)
    s_barrier
    ds_read_b128 v[116:119], v208 offset:0
    v_add_u32 v209, 24576, v209
    v_mfma_f32_16x16x32_bf16 v[100:103], v[152:155], a[252:255], v[100:103]
    ds_read_b128 v[120:123], v209 offset:0
    v_add_u32 v210, 24576, v210
    v_mfma_f32_16x16x32_bf16 v[100:103], v[156:159], v[4:7], v[100:103]
    ds_read_b128 v[124:127], v208 offset:128
    v_cvt_pk_bf16_f32 v56, v44, v45
    v_mfma_f32_16x16x32_bf16 v[100:103], v[160:163], v[8:11], v[100:103]
    ds_read_b64_tr_b16 v[164:165], v210 offset:0
    v_add_u32 v211, 24576, v211
    v_mfma_f32_16x16x32_bf16 a[164:167], v[96:99], v[176:179], a[164:167]
    ds_read_b64_tr_b16 v[166:167], v210 offset:6144
    v_add_u32 v212, 24576, v212
    v_mfma_f32_16x16x32_bf16 a[164:167], v[92:95], v[172:175], a[164:167]
    ds_read_b64_tr_b16 v[168:169], v210 offset:12288
    v_exp_f32 v46, v46
    v_mfma_f32_16x16x32_bf16 a[176:179], v[84:87], v[180:183], a[176:179]
    ds_read_b128 v[128:131], v209 offset:128
    v_exp_f32 v47, v47
    v_mfma_f32_16x16x32_bf16 a[176:179], v[88:91], v[184:187], a[176:179]
    ds_read_b128 v[132:135], v208 offset:256
    v_exp_f32 v48, v48
    v_mfma_f32_16x16x32_bf16 a[180:183], v[96:99], v[184:187], a[180:183]
    ds_read_b128 v[136:139], v209 offset:256
    v_cvt_pk_bf16_f32 v57, v46, v47
    v_exp_f32 v49, v49
    v_mfma_f32_16x16x32_bf16 a[180:183], v[92:95], v[180:183], a[180:183]
    s_waitcnt lgkmcnt(8)
    v_exp_f32 v50, v50
    v_mfma_f32_16x16x32_bf16 v[44:47], v[116:119], a[192:195], v[188:191]
    s_waitcnt lgkmcnt(7)
    ds_read_b64_tr_b16 v[170:171], v210 offset:18432
    v_exp_f32 v51, v51
    v_mfma_f32_16x16x32_bf16 v[44:47], v[120:123], a[196:199], v[44:47]
    s_waitcnt lgkmcnt(7)
    v_exp_f32 v36, v36
    v_mfma_f32_16x16x32_bf16 v[44:47], v[124:127], a[200:203], v[44:47]
    s_waitcnt lgkmcnt(3)
    v_exp_f32 v37, v37
    v_mfma_f32_16x16x32_bf16 v[44:47], v[128:131], a[204:207], v[44:47]
    s_waitcnt lgkmcnt(2)
    v_exp_f32 v38, v38
    v_mfma_f32_16x16x32_bf16 v[44:47], v[132:135], a[208:211], v[44:47]
    s_waitcnt lgkmcnt(1)
    v_exp_f32 v39, v39
    v_mfma_f32_16x16x32_bf16 v[44:47], v[136:139], a[212:215], v[44:47]
    v_cvt_pk_bf16_f32 v58, v36, v37
    v_cvt_pk_bf16_f32 v59, v38, v39
    v_mfma_f32_16x16x32_bf16 a[0:3], v[52:55], v[164:167], a[0:3]
    s_waitcnt lgkmcnt(0)
    v_cvt_pk_bf16_f32 v64, v48, v49
    v_cvt_pk_bf16_f32 v65, v50, v51
    v_mfma_f32_16x16x32_bf16 a[0:3], v[56:59], v[168:171], a[0:3]
    ds_read_b64_tr_b16 v[172:173], v211 offset:0
    v_max3_f32 v236, v100, v101, v102
    v_mfma_f32_16x16x32_bf16 v[48:51], v[116:119], a[216:219], v[192:195]
    ds_read_b64_tr_b16 v[174:175], v211 offset:6144
    v_max_f32 v236, v236, v103
    v_mfma_f32_16x16x32_bf16 v[48:51], v[120:123], a[220:223], v[48:51]
    v_exp_f32 v40, v40
    v_mfma_f32_16x16x32_bf16 v[48:51], v[124:127], a[224:227], v[48:51]
    v_exp_f32 v41, v41
    v_mfma_f32_16x16x32_bf16 v[48:51], v[128:131], a[228:231], v[48:51]
    v_exp_f32 v42, v42
    v_mfma_f32_16x16x32_bf16 v[48:51], v[132:135], a[232:235], v[48:51]
    v_exp_f32 v43, v43
    v_mfma_f32_16x16x32_bf16 v[48:51], v[136:139], a[236:239], v[48:51]
    v_cvt_pk_bf16_f32 v66, v40, v41
    v_cvt_pk_bf16_f32 v67, v42, v43
    v_mfma_f32_16x16x32_bf16 a[4:7], v[60:63], v[164:167], a[4:7]
    v_mov_b32 v237, v236
    s_nop 1
    v_permlane32_swap_b32 v237, v236
    s_nop 0
    v_max_f32 v236, v237, v236
    v_mov_b32 v237, v236
    s_nop 0
    s_nop 0
    v_permlane16_swap_b32 v237, v236
    s_nop 0
    v_max_f32 v236, v237, v236
    v_min_f32 v196, v196, -v236
    v_min_f32 v197, v197, -v236
    v_min_f32 v198, v198, -v236
    v_min_f32 v199, v199, -v236
    v_mfma_f32_16x16x32_bf16 a[4:7], v[64:67], v[168:171], a[4:7]
    ds_read_b64_tr_b16 v[176:177], v211 offset:12288
    v_add_u32 v213, 24576, v213
    v_mfma_f32_16x16x32_bf16 v[36:39], v[116:119], a[240:243], v[196:199]
    ds_read_b64_tr_b16 v[178:179], v211 offset:18432
    v_exp_f32 v44, v44
    v_mfma_f32_16x16x32_bf16 v[36:39], v[120:123], a[244:247], v[36:39]
    ds_read_b128 v[140:143], v208 offset:6144
    v_exp_f32 v45, v45
    v_mfma_f32_16x16x32_bf16 v[36:39], v[124:127], a[248:251], v[36:39]
    s_waitcnt vmcnt(6)
    ds_read_b128 v[144:147], v209 offset:6144
    ds_read_b128 v[12:15], v240 offset:0
    v_mfma_f32_16x16x32_bf16 v[36:39], v[128:131], a[252:255], v[36:39]
    ds_read_b128 v[148:151], v208 offset:6272
    ds_read_b128 v[16:19], v241 offset:0
    v_mfma_f32_16x16x32_bf16 v[36:39], v[132:135], v[4:7], v[36:39]
    ds_read_b128 v[152:155], v209 offset:6272
    ds_read_b128 v[20:23], v240 offset:128
    v_mfma_f32_16x16x32_bf16 v[36:39], v[136:139], v[8:11], v[36:39]
    s_waitcnt lgkmcnt(9)
    ds_read_b128 v[156:159], v208 offset:6400
    ds_read_b128 v[24:27], v241 offset:128
    v_mfma_f32_16x16x32_bf16 a[16:19], v[52:55], v[172:175], a[16:19]
    s_waitcnt lgkmcnt(9)
    ds_read_b128 v[160:163], v209 offset:6400
    ds_read_b128 v[28:31], v240 offset:256
    v_mfma_f32_16x16x32_bf16 a[16:19], v[56:59], v[176:179], a[16:19]
    s_waitcnt lgkmcnt(10)
    ds_read_b128 v[32:35], v241 offset:256
    v_cvt_pk_bf16_f32 v84, v44, v45
    v_mfma_f32_16x16x32_bf16 v[40:43], v[140:143], a[192:195], v[188:191]
    s_waitcnt lgkmcnt(10)
    v_exp_f32 v46, v46
    v_mfma_f32_16x16x32_bf16 v[40:43], v[144:147], a[196:199], v[40:43]
    s_waitcnt lgkmcnt(8)
    ds_read_b64_tr_b16 v[180:181], v212 offset:0
    v_lshlrev_b32 v220, 16, v12
    v_mfma_f32_16x16x32_bf16 v[40:43], v[148:151], a[200:203], v[40:43]
    s_waitcnt lgkmcnt(7)
    v_exp_f32 v47, v47
    v_mfma_f32_16x16x32_bf16 v[40:43], v[152:155], a[204:207], v[40:43]
    s_waitcnt lgkmcnt(5)
    ds_read_b64_tr_b16 v[182:183], v212 offset:6144
    v_cvt_pk_bf16_f32 v85, v46, v47
    v_mfma_f32_16x16x32_bf16 v[40:43], v[156:159], a[208:211], v[40:43]
    s_waitcnt lgkmcnt(4)
    v_exp_f32 v48, v48
    v_mfma_f32_16x16x32_bf16 v[40:43], v[160:163], a[212:215], v[40:43]
    v_exp_f32 v49, v49
    v_mfma_f32_16x16x32_bf16 a[20:23], v[60:63], v[172:175], a[20:23]
    s_waitcnt lgkmcnt(2)
    buffer_load_dwordx4 v214, s[12:15], s24 offen offset:0 lds
    v_mfma_f32_16x16x32_bf16 a[20:23], v[64:67], v[176:179], a[20:23]
    ds_read_b64_tr_b16 v[184:185], v212 offset:12288
    v_cvt_pk_bf16_f32 v92, v48, v49
    v_mfma_f32_16x16x32_bf16 v[44:47], v[140:143], a[216:219], v[192:195]
    ds_read_b64_tr_b16 v[186:187], v212 offset:18432
    v_and_b32 v221, s39, v12
    v_mfma_f32_16x16x32_bf16 v[44:47], v[144:147], a[220:223], v[44:47]
    v_exp_f32 v50, v50
    v_mfma_f32_16x16x32_bf16 v[44:47], v[148:151], a[224:227], v[44:47]
    buffer_load_dwordx4 v215, s[12:15], s24 offen offset:1024 lds
    v_mfma_f32_16x16x32_bf16 v[44:47], v[152:155], a[228:231], v[44:47]
    v_exp_f32 v51, v51
    v_mfma_f32_16x16x32_bf16 v[44:47], v[156:159], a[232:235], v[44:47]
    ds_read_b128 v[116:119], v208 offset:12288
    v_cvt_pk_bf16_f32 v93, v50, v51
    v_mfma_f32_16x16x32_bf16 v[44:47], v[160:163], a[236:239], v[44:47]
    s_waitcnt lgkmcnt(3)
    v_exp_f32 v36, v36
    v_mfma_f32_16x16x32_bf16 a[32:35], v[52:55], v[180:183], a[32:35]
    s_waitcnt lgkmcnt(1)
    buffer_load_dwordx4 v216, s[12:15], s24 offen offset:2048 lds
    s_add_u32 m0, s28, 3072
    v_mfma_f32_16x16x32_bf16 a[32:35], v[56:59], v[184:187], a[32:35]
    v_exp_f32 v37, v37
    v_mfma_f32_16x16x32_bf16 v[48:51], v[140:143], a[240:243], v[196:199]
    ds_read_b128 v[120:123], v209 offset:12288
    v_cvt_pk_bf16_f32 v100, v36, v37
    v_mfma_f32_16x16x32_bf16 v[48:51], v[144:147], a[244:247], v[48:51]
    ds_read_b128 v[124:127], v208 offset:12416
    v_lshlrev_b32 v222, 16, v13
    v_mfma_f32_16x16x32_bf16 v[48:51], v[148:151], a[248:251], v[48:51]
    ds_read_b128 v[128:131], v209 offset:12416
    v_and_b32 v223, s39, v13
    v_mfma_f32_16x16x32_bf16 v[48:51], v[152:155], a[252:255], v[48:51]
    ds_read_b128 v[132:135], v208 offset:12544
    v_lshlrev_b32 v224, 16, v14
    v_mfma_f32_16x16x32_bf16 v[48:51], v[156:159], v[4:7], v[48:51]
    ds_read_b128 v[136:139], v209 offset:12544
    v_exp_f32 v38, v38
    buffer_load_dwordx4 v214, s[12:15], s26 offen offset:0 lds
    v_mfma_f32_16x16x32_bf16 v[48:51], v[160:163], v[8:11], v[48:51]
    ds_read_b64_tr_b16 v[164:165], v213 offset:0
    v_exp_f32 v39, v39
    v_mfma_f32_16x16x32_bf16 a[36:39], v[60:63], v[180:183], a[36:39]
    ds_read_b64_tr_b16 v[166:167], v213 offset:6144
    v_cvt_pk_bf16_f32 v101, v38, v39
    v_mfma_f32_16x16x32_bf16 a[36:39], v[64:67], v[184:187], a[36:39]
    s_waitcnt lgkmcnt(7)
    ds_read_b64_tr_b16 v[168:169], v213 offset:12288
    v_and_b32 v225, s39, v14
    v_mfma_f32_16x16x32_bf16 v[36:39], v[116:119], a[192:195], v[188:191]
    s_waitcnt lgkmcnt(7)
    ds_read_b64_tr_b16 v[170:171], v213 offset:18432
    v_lshlrev_b32 v226, 16, v15
    v_mfma_f32_16x16x32_bf16 v[36:39], v[120:123], a[196:199], v[36:39]
    s_waitcnt lgkmcnt(7)
    buffer_load_dwordx4 v215, s[12:15], s26 offen offset:1024 lds
    v_mfma_f32_16x16x32_bf16 v[36:39], v[124:127], a[200:203], v[36:39]
    s_waitcnt lgkmcnt(6)
    v_exp_f32 v40, v40
    v_mfma_f32_16x16x32_bf16 v[36:39], v[128:131], a[204:207], v[36:39]
    s_waitcnt lgkmcnt(5)
    v_exp_f32 v41, v41
    v_mfma_f32_16x16x32_bf16 v[36:39], v[132:135], a[208:211], v[36:39]
    s_waitcnt lgkmcnt(4)
    v_exp_f32 v42, v42
    v_mfma_f32_16x16x32_bf16 v[36:39], v[136:139], a[212:215], v[36:39]
    s_waitcnt lgkmcnt(2)
    v_exp_f32 v43, v43
    v_mfma_f32_16x16x32_bf16 a[48:51], v[52:55], v[164:167], a[48:51]
    s_waitcnt lgkmcnt(0)
    v_cvt_pk_bf16_f32 v86, v40, v41
    v_cvt_pk_bf16_f32 v87, v42, v43
    v_mfma_f32_16x16x32_bf16 a[48:51], v[56:59], v[168:171], a[48:51]
    buffer_load_dwordx4 v216, s[12:15], s26 offen offset:2048 lds
    s_mov_b32 s24, 49152
    s_mov_b32 s26, 52224
    s_add_u32 s28, s60, 24576
    s_mov_b32 m0, s28
    v_mfma_f32_16x16x32_bf16 v[40:43], v[116:119], a[216:219], v[192:195]
    v_exp_f32 v44, v44
    v_mfma_f32_16x16x32_bf16 v[40:43], v[120:123], a[220:223], v[40:43]
    v_exp_f32 v45, v45
    v_mfma_f32_16x16x32_bf16 v[40:43], v[124:127], a[224:227], v[40:43]
    ds_read_b64_tr_b16 v[172:173], v210 offset:128
    v_cvt_pk_bf16_f32 v94, v44, v45
    v_mfma_f32_16x16x32_bf16 v[40:43], v[128:131], a[228:231], v[40:43]
    buffer_load_dwordx4 v214, s[12:15], s24 offen offset:0 lds
    v_mfma_f32_16x16x32_bf16 v[40:43], v[132:135], a[232:235], v[40:43]
    v_exp_f32 v46, v46
    v_mfma_f32_16x16x32_bf16 v[40:43], v[136:139], a[236:239], v[40:43]
    v_exp_f32 v47, v47
    v_mfma_f32_16x16x32_bf16 a[52:55], v[60:63], v[164:167], a[52:55]
    ds_read_b64_tr_b16 v[174:175], v210 offset:6272
    v_cvt_pk_bf16_f32 v95, v46, v47
    v_mfma_f32_16x16x32_bf16 a[52:55], v[64:67], v[168:171], a[52:55]
    ds_read_b64_tr_b16 v[176:177], v210 offset:12416
    v_and_b32 v227, s39, v15
    v_mfma_f32_16x16x32_bf16 v[44:47], v[116:119], a[240:243], v[196:199]
    ds_read_b64_tr_b16 v[178:179], v210 offset:18560
    v_mul_f32 v220, s62, v220
    v_mfma_f32_16x16x32_bf16 v[44:47], v[120:123], a[244:247], v[44:47]
    ds_read_b128 v[140:143], v208 offset:18432
    buffer_load_dwordx4 v215, s[12:15], s24 offen offset:1024 lds
    v_mfma_f32_16x16x32_bf16 v[44:47], v[124:127], a[248:251], v[44:47]
    ds_read_b128 v[144:147], v209 offset:18432
    v_exp_f32 v48, v48
    v_mfma_f32_16x16x32_bf16 v[44:47], v[128:131], a[252:255], v[44:47]
    ds_read_b128 v[148:151], v208 offset:18560
    v_exp_f32 v49, v49
    v_mfma_f32_16x16x32_bf16 v[44:47], v[132:135], v[4:7], v[44:47]
    ds_read_b128 v[152:155], v209 offset:18560
    v_exp_f32 v50, v50
    v_mfma_f32_16x16x32_bf16 v[44:47], v[136:139], v[8:11], v[44:47]
    s_waitcnt lgkmcnt(6)
    ds_read_b128 v[156:159], v208 offset:18688
    v_exp_f32 v51, v51
    v_mfma_f32_16x16x32_bf16 a[64:67], v[52:55], v[172:175], a[64:67]
    s_waitcnt lgkmcnt(5)
    ds_read_b128 v[160:163], v209 offset:18688
    v_cvt_pk_bf16_f32 v102, v48, v49
    v_cvt_pk_bf16_f32 v103, v50, v51
    v_mfma_f32_16x16x32_bf16 a[64:67], v[56:59], v[176:179], a[64:67]
    s_waitcnt lgkmcnt(5)
    buffer_load_dwordx4 v216, s[12:15], s24 offen offset:2048 lds
    s_add_u32 m0, s28, 3072
    v_mfma_f32_16x16x32_bf16 v[48:51], v[140:143], a[192:195], v[188:191]
    s_waitcnt lgkmcnt(4)
    v_exp_f32 v36, v36
    v_mfma_f32_16x16x32_bf16 v[48:51], v[144:147], a[196:199], v[48:51]
    s_waitcnt lgkmcnt(3)
    v_exp_f32 v37, v37
    v_mfma_f32_16x16x32_bf16 v[48:51], v[148:151], a[200:203], v[48:51]
    s_waitcnt lgkmcnt(2)
    ds_read_b64_tr_b16 v[180:181], v211 offset:128
    v_cvt_pk_bf16_f32 v88, v36, v37
    v_mfma_f32_16x16x32_bf16 v[48:51], v[152:155], a[204:207], v[48:51]
    s_waitcnt lgkmcnt(2)
    buffer_load_dwordx4 v214, s[12:15], s26 offen offset:0 lds
    v_mfma_f32_16x16x32_bf16 v[48:51], v[156:159], a[208:211], v[48:51]
    s_waitcnt lgkmcnt(1)
    v_exp_f32 v38, v38
    v_mfma_f32_16x16x32_bf16 v[48:51], v[160:163], a[212:215], v[48:51]
    v_exp_f32 v39, v39
    v_mfma_f32_16x16x32_bf16 a[68:71], v[60:63], v[172:175], a[68:71]
    ds_read_b64_tr_b16 v[182:183], v211 offset:6272
    v_cvt_pk_bf16_f32 v89, v38, v39
    v_mfma_f32_16x16x32_bf16 a[68:71], v[64:67], v[176:179], a[68:71]
    ds_read_b64_tr_b16 v[184:185], v211 offset:12416
    v_mul_f32 v221, s62, v221
    v_mfma_f32_16x16x32_bf16 v[36:39], v[140:143], a[216:219], v[192:195]
    ds_read_b64_tr_b16 v[186:187], v211 offset:18560
    v_mul_f32 v222, s62, v222
    v_mfma_f32_16x16x32_bf16 v[36:39], v[144:147], a[220:223], v[36:39]
    buffer_load_dwordx4 v215, s[12:15], s26 offen offset:1024 lds
    v_mfma_f32_16x16x32_bf16 v[36:39], v[148:151], a[224:227], v[36:39]
    v_exp_f32 v40, v40
    v_mfma_f32_16x16x32_bf16 v[36:39], v[152:155], a[228:231], v[36:39]
    v_exp_f32 v41, v41
    v_mfma_f32_16x16x32_bf16 v[36:39], v[156:159], a[232:235], v[36:39]
    v_exp_f32 v42, v42
    v_mfma_f32_16x16x32_bf16 v[36:39], v[160:163], a[236:239], v[36:39]
    s_waitcnt lgkmcnt(2)
    v_exp_f32 v43, v43
    v_mfma_f32_16x16x32_bf16 a[80:83], v[52:55], v[180:183], a[80:83]
    s_waitcnt lgkmcnt(0)
    v_cvt_pk_bf16_f32 v96, v40, v41
    v_cvt_pk_bf16_f32 v97, v42, v43
    v_mfma_f32_16x16x32_bf16 a[80:83], v[56:59], v[184:187], a[80:83]
    buffer_load_dwordx4 v216, s[12:15], s26 offen offset:2048 lds
    s_mov_b32 s25, 24576
    s_mov_b32 s27, 27648
    s_add_u32 s29, s60, 73728
    s_mov_b32 m0, s29
    v_mfma_f32_16x16x32_bf16 v[40:43], v[140:143], a[240:243], v[196:199]
    v_exp_f32 v44, v44
    v_mfma_f32_16x16x32_bf16 v[40:43], v[144:147], a[244:247], v[40:43]
    v_exp_f32 v45, v45
    v_mfma_f32_16x16x32_bf16 v[40:43], v[148:151], a[248:251], v[40:43]
    ds_read_b64_tr_b16 v[164:165], v212 offset:128
    v_cvt_pk_bf16_f32 v104, v44, v45
    v_mfma_f32_16x16x32_bf16 v[40:43], v[152:155], a[252:255], v[40:43]
    buffer_load_dwordx4 v214, s[16:19], s25 offen offset:0 lds
    v_mfma_f32_16x16x32_bf16 v[40:43], v[156:159], v[4:7], v[40:43]
    v_exp_f32 v46, v46
    v_mfma_f32_16x16x32_bf16 v[40:43], v[160:163], v[8:11], v[40:43]
    v_exp_f32 v47, v47
    v_mfma_f32_16x16x32_bf16 a[84:87], v[60:63], v[180:183], a[84:87]
    v_mul_f32 v223, s62, v223
    v_mul_f32 v224, s62, v224
    v_mul_f32 v225, s62, v225
    v_mul_f32 v226, s62, v226
    v_mul_f32 v227, s62, v227
    v_cvt_pk_bf16_f32 v12, v220, v221
    v_cvt_pk_bf16_f32 v13, v222, v223
    v_cvt_pk_bf16_f32 v14, v224, v225
    v_cvt_pk_bf16_f32 v15, v226, v227
    v_lshlrev_b32 v228, 16, v16
    v_and_b32 v229, s39, v16
    v_lshlrev_b32 v230, 16, v17
    v_and_b32 v231, s39, v17
    v_lshlrev_b32 v232, 16, v18
    v_and_b32 v233, s39, v18
    v_lshlrev_b32 v234, 16, v19
    v_and_b32 v235, s39, v19
    v_pk_mul_f32 v[228:229], s[62:63], v[228:229]
    v_pk_mul_f32 v[230:231], s[62:63], v[230:231]
    v_pk_mul_f32 v[232:233], s[62:63], v[232:233]
    v_pk_mul_f32 v[234:235], s[62:63], v[234:235]
    v_cvt_pk_bf16_f32 v16, v228, v229
    v_cvt_pk_bf16_f32 v17, v230, v231
    v_cvt_pk_bf16_f32 v18, v232, v233
    v_cvt_pk_bf16_f32 v19, v234, v235
    v_lshlrev_b32 v220, 16, v20
    v_and_b32 v221, s39, v20
    v_lshlrev_b32 v222, 16, v21
    v_and_b32 v223, s39, v21
    v_lshlrev_b32 v224, 16, v22
    v_and_b32 v225, s39, v22
    v_lshlrev_b32 v226, 16, v23
    v_and_b32 v227, s39, v23
    v_pk_mul_f32 v[220:221], s[62:63], v[220:221]
    v_pk_mul_f32 v[222:223], s[62:63], v[222:223]
    v_pk_mul_f32 v[224:225], s[62:63], v[224:225]
    v_pk_mul_f32 v[226:227], s[62:63], v[226:227]
    v_cvt_pk_bf16_f32 v20, v220, v221
    v_cvt_pk_bf16_f32 v21, v222, v223
    v_cvt_pk_bf16_f32 v22, v224, v225
    v_cvt_pk_bf16_f32 v23, v226, v227
    v_lshlrev_b32 v228, 16, v24
    v_and_b32 v229, s39, v24
    v_lshlrev_b32 v230, 16, v25
    v_and_b32 v231, s39, v25
    v_lshlrev_b32 v232, 16, v26
    v_and_b32 v233, s39, v26
    v_lshlrev_b32 v234, 16, v27
    v_and_b32 v235, s39, v27
    v_pk_mul_f32 v[228:229], s[62:63], v[228:229]
    v_pk_mul_f32 v[230:231], s[62:63], v[230:231]
    v_pk_mul_f32 v[232:233], s[62:63], v[232:233]
    v_pk_mul_f32 v[234:235], s[62:63], v[234:235]
    v_cvt_pk_bf16_f32 v24, v228, v229
    v_cvt_pk_bf16_f32 v25, v230, v231
    v_cvt_pk_bf16_f32 v26, v232, v233
    v_cvt_pk_bf16_f32 v27, v234, v235
    v_lshlrev_b32 v220, 16, v28
    v_and_b32 v221, s39, v28
    v_lshlrev_b32 v222, 16, v29
    v_and_b32 v223, s39, v29
    v_lshlrev_b32 v224, 16, v30
    v_and_b32 v225, s39, v30
    v_lshlrev_b32 v226, 16, v31
    v_and_b32 v227, s39, v31
    v_pk_mul_f32 v[220:221], s[62:63], v[220:221]
    v_pk_mul_f32 v[222:223], s[62:63], v[222:223]
    v_pk_mul_f32 v[224:225], s[62:63], v[224:225]
    v_pk_mul_f32 v[226:227], s[62:63], v[226:227]
    v_cvt_pk_bf16_f32 v28, v220, v221
    v_cvt_pk_bf16_f32 v29, v222, v223
    v_cvt_pk_bf16_f32 v30, v224, v225
    v_cvt_pk_bf16_f32 v31, v226, v227
    v_lshlrev_b32 v228, 16, v32
    v_and_b32 v229, s39, v32
    v_lshlrev_b32 v230, 16, v33
    v_and_b32 v231, s39, v33
    v_lshlrev_b32 v232, 16, v34
    v_and_b32 v233, s39, v34
    v_lshlrev_b32 v234, 16, v35
    v_and_b32 v235, s39, v35
    v_pk_mul_f32 v[228:229], s[62:63], v[228:229]
    v_pk_mul_f32 v[230:231], s[62:63], v[230:231]
    v_pk_mul_f32 v[232:233], s[62:63], v[232:233]
    v_pk_mul_f32 v[234:235], s[62:63], v[234:235]
    v_cvt_pk_bf16_f32 v32, v228, v229
    v_cvt_pk_bf16_f32 v33, v230, v231
    v_cvt_pk_bf16_f32 v34, v232, v233
    v_cvt_pk_bf16_f32 v35, v234, v235
    v_mfma_f32_16x16x32_bf16 a[84:87], v[64:67], v[184:187], a[84:87]
    buffer_load_dwordx4 v215, s[16:19], s25 offen offset:1024 lds
    v_mfma_f32_16x16x32_bf16 v[108:111], v[140:143], v[12:15], 0
    ds_read_b64_tr_b16 v[166:167], v212 offset:6272
    v_cvt_pk_bf16_f32 v105, v46, v47
    v_mfma_f32_16x16x32_bf16 v[108:111], v[144:147], v[16:19], v[108:111]
    ds_read_b64_tr_b16 v[168:169], v212 offset:12416
    v_exp_f32 v48, v48
    v_mfma_f32_16x16x32_bf16 v[108:111], v[148:151], v[20:23], v[108:111]
    ds_read_b64_tr_b16 v[170:171], v212 offset:18560
    v_exp_f32 v49, v49
    v_mfma_f32_16x16x32_bf16 v[108:111], v[152:155], v[24:27], v[108:111]
    ds_read_b64_tr_b16 v[172:173], v213 offset:128
    v_cvt_pk_bf16_f32 v90, v48, v49
    v_mfma_f32_16x16x32_bf16 v[108:111], v[156:159], v[28:31], v[108:111]
    ds_read_b64_tr_b16 v[174:175], v213 offset:6272
    v_exp_f32 v50, v50
    v_mfma_f32_16x16x32_bf16 v[108:111], v[160:163], v[32:35], v[108:111]
    ds_read_b64_tr_b16 v[176:177], v213 offset:12416
    buffer_load_dwordx4 v216, s[16:19], s25 offen offset:2048 lds
    s_add_u32 m0, s29, 3072
    v_smfmac_f32_16x16x64_bf16 v[204:207], v[244:247], v[52:59], v218
    ds_read_b64_tr_b16 v[178:179], v213 offset:18560
    v_exp_f32 v51, v51
    v_smfmac_f32_16x16x64_bf16 v[204:207], v[248:251], v[60:67], v218
    s_waitcnt lgkmcnt(6)
    ds_read_b64_tr_b16 v[180:181], v210 offset:256
    v_cvt_pk_bf16_f32 v91, v50, v51
    v_mfma_f32_16x16x32_bf16 a[96:99], v[52:55], v[164:167], a[96:99]
    s_waitcnt lgkmcnt(5)
    ds_read_b64_tr_b16 v[182:183], v210 offset:6400
    v_max3_f32 v236, v108, v109, v110
    v_mfma_f32_16x16x32_bf16 a[96:99], v[56:59], v[168:171], a[96:99]
    buffer_load_dwordx4 v214, s[16:19], s27 offen offset:0 lds
    v_mfma_f32_16x16x32_bf16 a[100:103], v[60:63], v[164:167], a[100:103]
    ds_read_b64_tr_b16 v[184:185], v210 offset:12544
    v_max_f32 v236, v236, v111
    v_mfma_f32_16x16x32_bf16 a[100:103], v[64:67], v[168:171], a[100:103]
    s_waitcnt lgkmcnt(5)
    ds_read_b64_tr_b16 v[186:187], v210 offset:18688
    v_mov_b32 v237, v236
    v_mfma_f32_16x16x32_bf16 a[112:115], v[52:55], v[172:175], a[112:115]
    s_waitcnt lgkmcnt(4)
    ds_read_b64_tr_b16 v[164:165], v211 offset:256
    v_permlane32_swap_b32 v237, v236
    v_mfma_f32_16x16x32_bf16 a[112:115], v[56:59], v[176:179], a[112:115]
    buffer_load_dwordx4 v215, s[16:19], s27 offen offset:1024 lds
    v_mfma_f32_16x16x32_bf16 a[116:119], v[60:63], v[172:175], a[116:119]
    v_max_f32 v236, v237, v236
    v_mov_b32 v237, v236
    s_nop 0
    s_nop 0
    v_permlane16_swap_b32 v237, v236
    s_nop 0
    v_max_f32 v236, v237, v236
    v_min_f32 v200, v200, -v236
    v_min_f32 v201, v201, -v236
    v_min_f32 v202, v202, -v236
    v_min_f32 v203, v203, -v236
    v_mfma_f32_16x16x32_bf16 a[116:119], v[64:67], v[176:179], a[116:119]
    ds_read_b64_tr_b16 v[166:167], v211 offset:6400
    v_add_u32 v210, 24576, v210
    v_mfma_f32_16x16x32_bf16 v[44:47], v[116:119], v[12:15], v[200:203]
    v_exp_f32 v36, v36
    v_mfma_f32_16x16x32_bf16 v[44:47], v[120:123], v[16:19], v[44:47]
    buffer_load_dwordx4 v216, s[16:19], s27 offen offset:2048 lds
    v_mfma_f32_16x16x32_bf16 v[44:47], v[124:127], v[20:23], v[44:47]
    v_exp_f32 v37, v37
    v_mfma_f32_16x16x32_bf16 v[44:47], v[128:131], v[24:27], v[44:47]
    ds_read_b64_tr_b16 v[168:169], v211 offset:12544
    v_cvt_pk_bf16_f32 v98, v36, v37
    v_mfma_f32_16x16x32_bf16 v[44:47], v[132:135], v[28:31], v[44:47]
    ds_read_b64_tr_b16 v[170:171], v211 offset:18688
    v_add_u32 v211, 24576, v211
    v_mfma_f32_16x16x32_bf16 v[44:47], v[136:139], v[32:35], v[44:47]
    s_waitcnt lgkmcnt(6)
    ds_read_b128 v[116:119], v208 offset:0
    v_exp_f32 v38, v38
    v_mfma_f32_16x16x32_bf16 a[128:131], v[52:55], v[180:183], a[128:131]
    s_waitcnt lgkmcnt(5)
    ds_read_b128 v[120:123], v209 offset:0
    v_exp_f32 v39, v39
    v_mfma_f32_16x16x32_bf16 a[128:131], v[56:59], v[184:187], a[128:131]
    ds_read_b128 v[124:127], v208 offset:128
    v_cvt_pk_bf16_f32 v99, v38, v39
    v_mfma_f32_16x16x32_bf16 a[132:135], v[60:63], v[180:183], a[132:135]
    ds_read_b128 v[128:131], v209 offset:128
    v_exp_f32 v40, v40
    v_mfma_f32_16x16x32_bf16 a[132:135], v[64:67], v[184:187], a[132:135]
    s_waitcnt lgkmcnt(6)
    ds_read_b128 v[132:135], v208 offset:256
    v_exp_f32 v41, v41
    v_mfma_f32_16x16x32_bf16 a[144:147], v[52:55], v[164:167], a[144:147]
    s_waitcnt lgkmcnt(5)
    ds_read_b128 v[136:139], v209 offset:256
    v_cvt_pk_bf16_f32 v106, v40, v41
    v_mfma_f32_16x16x32_bf16 a[144:147], v[56:59], v[168:171], a[144:147]
    s_waitcnt lgkmcnt(5)
    ds_read_b64_tr_b16 v[172:173], v212 offset:256
    v_exp_f32 v42, v42
    v_mfma_f32_16x16x32_bf16 v[48:51], v[116:119], v[12:15], v[200:203]
    s_waitcnt lgkmcnt(5)
    ds_read_b64_tr_b16 v[174:175], v212 offset:6400
    v_exp_f32 v43, v43
    v_mfma_f32_16x16x32_bf16 v[48:51], v[120:123], v[16:19], v[48:51]
    s_waitcnt lgkmcnt(5)
    ds_read_b64_tr_b16 v[176:177], v212 offset:12544
    v_cvt_pk_bf16_f32 v107, v42, v43
    v_mfma_f32_16x16x32_bf16 v[48:51], v[124:127], v[20:23], v[48:51]
    s_waitcnt lgkmcnt(5)
    ds_read_b64_tr_b16 v[178:179], v212 offset:18688
    v_add_u32 v212, 24576, v212
    v_mfma_f32_16x16x32_bf16 v[48:51], v[128:131], v[24:27], v[48:51]
    s_waitcnt lgkmcnt(5)
    ds_read_b128 v[116:119], v208 offset:6144
    v_exp_f32 v44, v44
    v_mfma_f32_16x16x32_bf16 v[48:51], v[132:135], v[28:31], v[48:51]
    s_waitcnt lgkmcnt(5)
    ds_read_b128 v[120:123], v209 offset:6144
    v_exp_f32 v45, v45
    v_mfma_f32_16x16x32_bf16 v[48:51], v[136:139], v[32:35], v[48:51]
    ds_read_b128 v[124:127], v208 offset:6272
    v_cvt_pk_bf16_f32 v112, v44, v45
    v_mfma_f32_16x16x32_bf16 a[148:151], v[60:63], v[164:167], a[148:151]
    ds_read_b128 v[128:131], v209 offset:6272
    v_exp_f32 v46, v46
    v_mfma_f32_16x16x32_bf16 a[148:151], v[64:67], v[168:171], a[148:151]
    s_waitcnt lgkmcnt(6)
    ds_read_b128 v[132:135], v208 offset:6400
    v_add_u32 v208, -49152, v208
    v_mfma_f32_16x16x32_bf16 a[160:163], v[52:55], v[172:175], a[160:163]
    s_waitcnt lgkmcnt(5)
    ds_read_b128 v[136:139], v209 offset:6400
    v_add_u32 v209, -49152, v209
    v_mfma_f32_16x16x32_bf16 a[160:163], v[56:59], v[176:179], a[160:163]
    ds_read_b64_tr_b16 v[180:181], v213 offset:256
    v_exp_f32 v47, v47
    v_mfma_f32_16x16x32_bf16 a[164:167], v[60:63], v[172:175], a[164:167]
    ds_read_b64_tr_b16 v[182:183], v213 offset:6400
    v_cvt_pk_bf16_f32 v113, v46, v47
    v_mfma_f32_16x16x32_bf16 a[164:167], v[64:67], v[176:179], a[164:167]
    s_waitcnt lgkmcnt(7)
    ds_read_b64_tr_b16 v[184:185], v213 offset:12544
    v_exp_f32 v48, v48
    v_mfma_f32_16x16x32_bf16 v[36:39], v[116:119], v[12:15], v[200:203]
    s_waitcnt lgkmcnt(7)
    ds_read_b64_tr_b16 v[186:187], v213 offset:18688
    v_add_u32 v213, 24576, v213
    v_mfma_f32_16x16x32_bf16 v[36:39], v[120:123], v[16:19], v[36:39]
    s_waitcnt lgkmcnt(7)
    v_exp_f32 v49, v49
    v_mfma_f32_16x16x32_bf16 v[36:39], v[124:127], v[20:23], v[36:39]
    s_waitcnt lgkmcnt(6)
    v_exp_f32 v50, v50
    v_mfma_f32_16x16x32_bf16 v[36:39], v[128:131], v[24:27], v[36:39]
    s_waitcnt lgkmcnt(5)
    v_exp_f32 v51, v51
    v_mfma_f32_16x16x32_bf16 v[36:39], v[132:135], v[28:31], v[36:39]
    s_waitcnt vmcnt(12) lgkmcnt(0)
    s_barrier
    ds_read_b128 v[116:119], v208 offset:0
    v_cvt_pk_bf16_f32 v108, v48, v49
    v_cvt_pk_bf16_f32 v109, v50, v51
    v_mfma_f32_16x16x32_bf16 v[36:39], v[136:139], v[32:35], v[36:39]
    ds_read_b128 v[120:123], v209 offset:0
    v_mfma_f32_16x16x32_bf16 v[48:51], v[140:143], v[12:15], v[200:203]
    ds_read_b128 v[124:127], v208 offset:128
    v_mfma_f32_16x16x32_bf16 v[48:51], v[144:147], v[16:19], v[48:51]
    ds_read_b64_tr_b16 v[164:165], v210 offset:0
    v_mfma_f32_16x16x32_bf16 v[48:51], v[148:151], v[20:23], v[48:51]
    ds_read_b64_tr_b16 v[166:167], v210 offset:6144
    s_nop 0
    v_exp_f32 v36, v36
    v_mfma_f32_16x16x32_bf16 v[48:51], v[152:155], v[24:27], v[48:51]
    ds_read_b64_tr_b16 v[168:169], v210 offset:12288
    v_exp_f32 v37, v37
    v_mfma_f32_16x16x32_bf16 v[48:51], v[156:159], v[28:31], v[48:51]
    ds_read_b128 v[128:131], v209 offset:128
    v_cvt_pk_bf16_f32 v110, v36, v37
    v_mfma_f32_16x16x32_bf16 v[48:51], v[160:163], v[32:35], v[48:51]
    ds_read_b128 v[132:135], v208 offset:256
    v_exp_f32 v38, v38
    v_mfma_f32_16x16x32_bf16 a[176:179], v[52:55], v[180:183], a[176:179]
    ds_read_b128 v[136:139], v209 offset:256
    v_exp_f32 v39, v39
    v_mfma_f32_16x16x32_bf16 a[176:179], v[56:59], v[184:187], a[176:179]
    ds_read_b64_tr_b16 v[170:171], v210 offset:18432
    v_cvt_pk_bf16_f32 v111, v38, v39
    v_mfma_f32_16x16x32_bf16 a[180:183], v[60:63], v[180:183], a[180:183]
    ds_read_b64_tr_b16 v[172:173], v211 offset:0
    v_mfma_f32_16x16x32_bf16 a[180:183], v[64:67], v[184:187], a[180:183]
    s_waitcnt lgkmcnt(10)
    ds_read_b64_tr_b16 v[174:175], v211 offset:6144

L_join:
    s_mov_b32 s24, 73728
    s_mov_b32 s26, 76800
    s_mov_b32 s25, 49152
    s_mov_b32 s27, 52224
    s_add_u32 s28, s60, 49152
    s_add_u32 s29, s60, 98304
    s_mov_b32 s34, 0
    s_mov_b32 s30, -49152
    s_mov_b32 s37, 24576
    s_mov_b32 s38, 24576
    s_mov_b32 s31, 15
    s_branch L_mid
.p2align 6
L_loop:
    v_mfma_f32_16x16x32_bf16 v[36:39], v[116:119], a[192:195], v[188:191]
    v_exp_f32 v48, v48
    v_mfma_f32_16x16x32_bf16 v[36:39], v[120:123], a[196:199], v[36:39]
    ds_read_b128 v[140:143], v208 offset:6144
    v_mfma_f32_16x16x32_bf16 v[36:39], v[124:127], a[200:203], v[36:39]
    v_exp_f32 v49, v49
    v_mfma_f32_16x16x32_bf16 v[36:39], v[128:131], a[204:207], v[36:39]
    ds_read_b128 v[144:147], v209 offset:6144
    v_mfma_f32_16x16x32_bf16 v[36:39], v[132:135], a[208:211], v[36:39]
    s_waitcnt lgkmcnt(2)
    v_exp_f32 v50, v50
    v_mfma_f32_16x16x32_bf16 v[36:39], v[136:139], a[212:215], v[36:39]
    ds_read_b64_tr_b16 v[176:177], v211 offset:12288
    v_cvt_pk_bf16_f32 v82, v48, v49
    v_mfma_f32_16x16x32_bf16 v[40:43], v[136:139], a[236:239], v[192:195]
    v_exp_f32 v51, v51
    v_mfma_f32_16x16x32_bf16 v[40:43], v[132:135], a[232:235], v[40:43]
    ds_read_b64_tr_b16 v[178:179], v211 offset:18432
    v_mfma_f32_16x16x32_bf16 v[40:43], v[128:131], a[228:231], v[40:43]
    ds_read_b64_tr_b16 v[180:181], v212 offset:0
    v_mfma_f32_16x16x32_bf16 v[40:43], v[124:127], a[224:227], v[40:43]
    s_mov_b32 m0, s28
    v_cvt_pk_bf16_f32 v83, v50, v51
    v_mfma_f32_16x16x32_bf16 v[40:43], v[120:123], a[220:223], v[40:43]
    buffer_load_dwordx4 v214, s[12:15], s24 offen offset:0 lds
    v_mfma_f32_16x16x32_bf16 v[40:43], v[116:119], a[216:219], v[40:43]
    v_mfma_f32_16x16x32_bf16 v[44:47], v[116:119], a[240:243], v[196:199]
    v_exp_f32 v36, v36
    v_mfma_f32_16x16x32_bf16 v[44:47], v[120:123], a[244:247], v[44:47]
    ds_read_b128 v[148:151], v208 offset:6272
    v_mfma_f32_16x16x32_bf16 v[44:47], v[124:127], a[248:251], v[44:47]
    v_exp_f32 v37, v37
    v_mfma_f32_16x16x32_bf16 v[44:47], v[128:131], a[252:255], v[44:47]
    ds_read_b128 v[152:155], v209 offset:6272
    v_mfma_f32_16x16x32_bf16 v[44:47], v[132:135], v[4:7], v[44:47]
    v_exp_f32 v38, v38
    v_mfma_f32_16x16x32_bf16 v[44:47], v[136:139], v[8:11], v[44:47]
    ds_read_b64_tr_b16 v[182:183], v212 offset:6144
    v_cvt_pk_bf16_f32 v84, v36, v37
    v_mfma_f32_16x16x32_bf16 v[48:51], v[136:139], v[32:35], v[200:203]
    v_exp_f32 v39, v39
    v_mfma_f32_16x16x32_bf16 v[48:51], v[132:135], v[28:31], v[48:51]
    ds_read_b64_tr_b16 v[184:185], v212 offset:12288
    v_mfma_f32_16x16x32_bf16 v[48:51], v[128:131], v[24:27], v[48:51]
    ds_read_b64_tr_b16 v[186:187], v212 offset:18432
    v_mfma_f32_16x16x32_bf16 v[48:51], v[124:127], v[20:23], v[48:51]
    v_cvt_pk_bf16_f32 v85, v38, v39
    v_mfma_f32_16x16x32_bf16 v[48:51], v[120:123], v[16:19], v[48:51]
    buffer_load_dwordx4 v215, s[12:15], s24 offen offset:1024 lds
    v_mfma_f32_16x16x32_bf16 v[48:51], v[116:119], v[12:15], v[48:51]
    v_smfmac_f32_16x16x64_bf16 v[204:207], v[244:247], v[52:59], v218
    v_mfma_f32_16x16x32_bf16 a[0:3], v[52:55], v[164:167], a[0:3]
    v_exp_f32 v40, v40
    v_mfma_f32_16x16x32_bf16 a[0:3], v[56:59], v[168:171], a[0:3]
    s_waitcnt lgkmcnt(1)
    ds_read_b128 v[156:159], v208 offset:6400
    v_mfma_f32_16x16x32_bf16 a[16:19], v[56:59], v[176:179], a[16:19]
    v_exp_f32 v41, v41
    v_mfma_f32_16x16x32_bf16 a[16:19], v[52:55], v[172:175], a[16:19]
    ds_read_b128 v[160:163], v209 offset:6400
    v_mfma_f32_16x16x32_bf16 a[32:35], v[52:55], v[180:183], a[32:35]
    s_waitcnt lgkmcnt(2)
    v_exp_f32 v42, v42
    v_mfma_f32_16x16x32_bf16 a[32:35], v[56:59], v[184:187], a[32:35]
    ds_read_b64_tr_b16 v[220:221], v213 offset:0
    v_cvt_pk_bf16_f32 v92, v40, v41
    v_mfma_f32_16x16x32_bf16 a[36:39], v[64:67], v[184:187], a[36:39]
    v_exp_f32 v43, v43
    v_mfma_f32_16x16x32_bf16 a[36:39], v[60:63], v[180:183], a[36:39]
    ds_read_b64_tr_b16 v[222:223], v213 offset:6144
    v_mfma_f32_16x16x32_bf16 a[20:23], v[60:63], v[172:175], a[20:23]
    ds_read_b64_tr_b16 v[224:225], v213 offset:12288
    v_mfma_f32_16x16x32_bf16 a[20:23], v[64:67], v[176:179], a[20:23]
    v_cvt_pk_bf16_f32 v93, v42, v43
    v_mfma_f32_16x16x32_bf16 a[4:7], v[64:67], v[168:171], a[4:7]
    buffer_load_dwordx4 v216, s[12:15], s24 offen offset:2048 lds
    v_mfma_f32_16x16x32_bf16 a[4:7], v[60:63], v[164:167], a[4:7]
    v_mfma_f32_16x16x32_bf16 a[8:11], v[68:71], v[164:167], a[8:11]
    v_exp_f32 v44, v44
    v_mfma_f32_16x16x32_bf16 a[8:11], v[72:75], v[168:171], a[8:11]
    ds_read_b64_tr_b16 v[226:227], v213 offset:18432
    v_mfma_f32_16x16x32_bf16 a[24:27], v[72:75], v[176:179], a[24:27]
    v_exp_f32 v45, v45
    v_mfma_f32_16x16x32_bf16 a[24:27], v[68:71], v[172:175], a[24:27]
    ds_read_b64_tr_b16 v[232:233], v210 offset:12416
    v_mfma_f32_16x16x32_bf16 a[40:43], v[68:71], v[180:183], a[40:43]
    v_exp_f32 v46, v46
    v_mfma_f32_16x16x32_bf16 a[40:43], v[72:75], v[184:187], a[40:43]
    ds_read_b64_tr_b16 v[234:235], v210 offset:18560
    v_cvt_pk_bf16_f32 v100, v44, v45
    v_mfma_f32_16x16x32_bf16 a[44:47], v[80:83], v[184:187], a[44:47]
    v_exp_f32 v47, v47
    v_mfma_f32_16x16x32_bf16 a[44:47], v[76:79], v[180:183], a[44:47]
    ds_read_b64_tr_b16 v[228:229], v210 offset:128
    v_mfma_f32_16x16x32_bf16 a[28:31], v[76:79], v[172:175], a[28:31]
    ds_read_b64_tr_b16 v[230:231], v210 offset:6272
    v_mfma_f32_16x16x32_bf16 a[28:31], v[80:83], v[176:179], a[28:31]
    s_add_u32 m0, s28, 3072
    v_cvt_pk_bf16_f32 v101, v46, v47
    v_mfma_f32_16x16x32_bf16 a[12:15], v[80:83], v[168:171], a[12:15]
    buffer_load_dwordx4 v214, s[12:15], s26 offen offset:0 lds
    v_mfma_f32_16x16x32_bf16 a[12:15], v[76:79], v[164:167], a[12:15]
    v_mfma_f32_16x16x32_bf16 v[36:39], v[140:143], a[192:195], v[188:191]
    v_exp_f32 v48, v48
    v_mfma_f32_16x16x32_bf16 v[36:39], v[144:147], a[196:199], v[36:39]
    ds_read_b128 v[116:119], v208 offset:12288
    v_mfma_f32_16x16x32_bf16 v[36:39], v[148:151], a[200:203], v[36:39]
    v_exp_f32 v49, v49
    v_mfma_f32_16x16x32_bf16 v[36:39], v[152:155], a[204:207], v[36:39]
    s_waitcnt lgkmcnt(1)
    ds_read_b128 v[120:123], v209 offset:12288
    v_mfma_f32_16x16x32_bf16 v[36:39], v[156:159], a[208:211], v[36:39]
    v_exp_f32 v50, v50
    v_mfma_f32_16x16x32_bf16 v[36:39], v[160:163], a[212:215], v[36:39]
    ds_read_b64_tr_b16 v[236:237], v211 offset:128
    v_cvt_pk_bf16_f32 v108, v48, v49
    v_mfma_f32_16x16x32_bf16 v[40:43], v[160:163], a[236:239], v[192:195]
    v_exp_f32 v51, v51
    v_mfma_f32_16x16x32_bf16 v[40:43], v[156:159], a[232:235], v[40:43]
    ds_read_b64_tr_b16 v[238:239], v211 offset:6272
    v_mfma_f32_16x16x32_bf16 v[40:43], v[152:155], a[228:231], v[40:43]
    ds_read_b64_tr_b16 v[240:241], v211 offset:12416
    v_mfma_f32_16x16x32_bf16 v[40:43], v[148:151], a[224:227], v[40:43]
    v_cvt_pk_bf16_f32 v109, v50, v51
    v_mfma_f32_16x16x32_bf16 v[40:43], v[144:147], a[220:223], v[40:43]
    buffer_load_dwordx4 v215, s[12:15], s26 offen offset:1024 lds
    v_mfma_f32_16x16x32_bf16 v[40:43], v[140:143], a[216:219], v[40:43]
    v_mfma_f32_16x16x32_bf16 v[44:47], v[140:143], a[240:243], v[196:199]
    v_exp_f32 v36, v36
    v_mfma_f32_16x16x32_bf16 v[44:47], v[144:147], a[244:247], v[44:47]
    ds_read_b128 v[124:127], v208 offset:12416
    v_mfma_f32_16x16x32_bf16 v[44:47], v[148:151], a[248:251], v[44:47]
    v_exp_f32 v37, v37
    v_mfma_f32_16x16x32_bf16 v[44:47], v[152:155], a[252:255], v[44:47]
    ds_read_b128 v[128:131], v209 offset:12416
    v_mfma_f32_16x16x32_bf16 v[44:47], v[156:159], v[4:7], v[44:47]
    v_exp_f32 v38, v38
    v_mfma_f32_16x16x32_bf16 v[44:47], v[160:163], v[8:11], v[44:47]
    ds_read_b64_tr_b16 v[242:243], v211 offset:18560
    v_cvt_pk_bf16_f32 v86, v36, v37
    v_mfma_f32_16x16x32_bf16 v[48:51], v[160:163], v[32:35], v[200:203]
    v_exp_f32 v39, v39
    v_mfma_f32_16x16x32_bf16 v[48:51], v[156:159], v[28:31], v[48:51]
    v_mfma_f32_16x16x32_bf16 v[48:51], v[152:155], v[24:27], v[48:51]
    v_mfma_f32_16x16x32_bf16 v[48:51], v[148:151], v[20:23], v[48:51]
    v_cvt_pk_bf16_f32 v87, v38, v39
    v_mfma_f32_16x16x32_bf16 v[48:51], v[144:147], v[16:19], v[48:51]
    buffer_load_dwordx4 v216, s[12:15], s26 offen offset:2048 lds
    v_mfma_f32_16x16x32_bf16 v[48:51], v[140:143], v[12:15], v[48:51]
    v_smfmac_f32_16x16x64_bf16 v[204:207], v[248:251], v[60:67], v218
    v_mfma_f32_16x16x32_bf16 a[48:51], v[52:55], v[220:223], a[48:51]
    v_exp_f32 v40, v40
    v_mfma_f32_16x16x32_bf16 a[48:51], v[56:59], v[224:227], a[48:51]
    ds_read_b128 v[132:135], v208 offset:12544
    v_mfma_f32_16x16x32_bf16 a[64:67], v[56:59], v[232:235], a[64:67]
    v_exp_f32 v41, v41
    v_mfma_f32_16x16x32_bf16 a[64:67], v[52:55], v[228:231], a[64:67]
    s_waitcnt lgkmcnt(1)
    ds_read_b128 v[136:139], v209 offset:12544
    v_mfma_f32_16x16x32_bf16 a[80:83], v[52:55], v[236:239], a[80:83]
    v_exp_f32 v42, v42
    v_mfma_f32_16x16x32_bf16 a[80:83], v[56:59], v[240:243], a[80:83]
    ds_read_b64_tr_b16 v[164:165], v212 offset:128
    v_cvt_pk_bf16_f32 v94, v40, v41
    v_mfma_f32_16x16x32_bf16 a[84:87], v[64:67], v[240:243], a[84:87]
    v_exp_f32 v43, v43
    v_mfma_f32_16x16x32_bf16 a[84:87], v[60:63], v[236:239], a[84:87]
    ds_read_b64_tr_b16 v[166:167], v212 offset:6272
    v_mfma_f32_16x16x32_bf16 a[68:71], v[60:63], v[228:231], a[68:71]
    ds_read_b64_tr_b16 v[168:169], v212 offset:12416
    v_mfma_f32_16x16x32_bf16 a[68:71], v[64:67], v[232:235], a[68:71]
    s_mov_b32 m0, s29
    v_cvt_pk_bf16_f32 v95, v42, v43
    v_mfma_f32_16x16x32_bf16 a[52:55], v[64:67], v[224:227], a[52:55]
    buffer_load_dwordx4 v214, s[16:19], s25 offen offset:0 lds
    v_mfma_f32_16x16x32_bf16 a[52:55], v[60:63], v[220:223], a[52:55]
    v_mfma_f32_16x16x32_bf16 a[56:59], v[68:71], v[220:223], a[56:59]
    v_exp_f32 v44, v44
    v_mfma_f32_16x16x32_bf16 a[56:59], v[72:75], v[224:227], a[56:59]
    ds_read_b64_tr_b16 v[170:171], v212 offset:18560
    v_mfma_f32_16x16x32_bf16 a[72:75], v[72:75], v[232:235], a[72:75]
    v_exp_f32 v45, v45
    v_mfma_f32_16x16x32_bf16 a[72:75], v[68:71], v[228:231], a[72:75]
    ds_read_b64_tr_b16 v[176:177], v213 offset:12416
    v_mfma_f32_16x16x32_bf16 a[88:91], v[68:71], v[236:239], a[88:91]
    v_exp_f32 v46, v46
    v_mfma_f32_16x16x32_bf16 a[88:91], v[72:75], v[240:243], a[88:91]
    ds_read_b64_tr_b16 v[178:179], v213 offset:18560
    v_cvt_pk_bf16_f32 v102, v44, v45
    v_mfma_f32_16x16x32_bf16 a[92:95], v[80:83], v[240:243], a[92:95]
    v_exp_f32 v47, v47
    v_mfma_f32_16x16x32_bf16 a[92:95], v[76:79], v[236:239], a[92:95]
    ds_read_b64_tr_b16 v[172:173], v213 offset:128
    v_mfma_f32_16x16x32_bf16 a[76:79], v[76:79], v[228:231], a[76:79]
    ds_read_b64_tr_b16 v[174:175], v213 offset:6272
    v_mfma_f32_16x16x32_bf16 a[76:79], v[80:83], v[232:235], a[76:79]
    v_cvt_pk_bf16_f32 v103, v46, v47
    v_mfma_f32_16x16x32_bf16 a[60:63], v[80:83], v[224:227], a[60:63]
    buffer_load_dwordx4 v215, s[16:19], s25 offen offset:1024 lds
    v_mfma_f32_16x16x32_bf16 a[60:63], v[76:79], v[220:223], a[60:63]
    v_mfma_f32_16x16x32_bf16 v[36:39], v[116:119], a[192:195], v[188:191]
    v_exp_f32 v48, v48
    v_mfma_f32_16x16x32_bf16 v[36:39], v[120:123], a[196:199], v[36:39]
    ds_read_b128 v[140:143], v208 offset:18432
    v_mfma_f32_16x16x32_bf16 v[36:39], v[124:127], a[200:203], v[36:39]
    v_exp_f32 v49, v49
    v_mfma_f32_16x16x32_bf16 v[36:39], v[128:131], a[204:207], v[36:39]
    s_waitcnt lgkmcnt(1)
    ds_read_b128 v[144:147], v209 offset:18432
    v_mfma_f32_16x16x32_bf16 v[36:39], v[132:135], a[208:211], v[36:39]
    v_exp_f32 v50, v50
    v_mfma_f32_16x16x32_bf16 v[36:39], v[136:139], a[212:215], v[36:39]
    ds_read_b64_tr_b16 v[180:181], v210 offset:256
    v_cvt_pk_bf16_f32 v110, v48, v49
    v_mfma_f32_16x16x32_bf16 v[40:43], v[136:139], a[236:239], v[192:195]
    v_exp_f32 v51, v51
    v_mfma_f32_16x16x32_bf16 v[40:43], v[132:135], a[232:235], v[40:43]
    ds_read_b64_tr_b16 v[182:183], v210 offset:6400
    v_mfma_f32_16x16x32_bf16 v[40:43], v[128:131], a[228:231], v[40:43]
    ds_read_b64_tr_b16 v[184:185], v210 offset:12544
    v_mfma_f32_16x16x32_bf16 v[40:43], v[124:127], a[224:227], v[40:43]
    v_cvt_pk_bf16_f32 v111, v50, v51
    v_mfma_f32_16x16x32_bf16 v[40:43], v[120:123], a[220:223], v[40:43]
    buffer_load_dwordx4 v216, s[16:19], s25 offen offset:2048 lds
    v_mfma_f32_16x16x32_bf16 v[40:43], v[116:119], a[216:219], v[40:43]
    v_mfma_f32_16x16x32_bf16 v[44:47], v[116:119], a[240:243], v[196:199]
    v_exp_f32 v36, v36
    v_mfma_f32_16x16x32_bf16 v[44:47], v[120:123], a[244:247], v[44:47]
    ds_read_b128 v[148:151], v208 offset:18560
    v_mfma_f32_16x16x32_bf16 v[44:47], v[124:127], a[248:251], v[44:47]
    v_exp_f32 v37, v37
    v_mfma_f32_16x16x32_bf16 v[44:47], v[128:131], a[252:255], v[44:47]
    ds_read_b128 v[152:155], v209 offset:18560
    v_mfma_f32_16x16x32_bf16 v[44:47], v[132:135], v[4:7], v[44:47]
    v_exp_f32 v38, v38
    v_mfma_f32_16x16x32_bf16 v[44:47], v[136:139], v[8:11], v[44:47]
    ds_read_b64_tr_b16 v[186:187], v210 offset:18688
    v_cvt_pk_bf16_f32 v88, v36, v37
    v_mfma_f32_16x16x32_bf16 v[48:51], v[136:139], v[32:35], v[200:203]
    v_exp_f32 v39, v39
    v_mfma_f32_16x16x32_bf16 v[48:51], v[132:135], v[28:31], v[48:51]
    v_mfma_f32_16x16x32_bf16 v[48:51], v[128:131], v[24:27], v[48:51]
    v_mfma_f32_16x16x32_bf16 v[48:51], v[124:127], v[20:23], v[48:51]
    s_add_u32 m0, s29, 3072
    v_cvt_pk_bf16_f32 v89, v38, v39
    v_mfma_f32_16x16x32_bf16 v[48:51], v[120:123], v[16:19], v[48:51]
    buffer_load_dwordx4 v214, s[16:19], s27 offen offset:0 lds
    v_mfma_f32_16x16x32_bf16 v[48:51], v[116:119], v[12:15], v[48:51]
    v_smfmac_f32_16x16x64_bf16 v[252:255], v[244:247], v[68:75], v218
    v_mfma_f32_16x16x32_bf16 a[96:99], v[52:55], v[164:167], a[96:99]
    v_exp_f32 v40, v40
    v_mfma_f32_16x16x32_bf16 a[96:99], v[56:59], v[168:171], a[96:99]
    ds_read_b128 v[156:159], v208 offset:18688
    v_mfma_f32_16x16x32_bf16 a[112:115], v[56:59], v[176:179], a[112:115]
    v_exp_f32 v41, v41
    v_mfma_f32_16x16x32_bf16 a[112:115], v[52:55], v[172:175], a[112:115]
    s_waitcnt lgkmcnt(1)
    ds_read_b128 v[160:163], v209 offset:18688
    v_mfma_f32_16x16x32_bf16 a[128:131], v[52:55], v[180:183], a[128:131]
    v_exp_f32 v42, v42
    v_mfma_f32_16x16x32_bf16 a[128:131], v[56:59], v[184:187], a[128:131]
    ds_read_b64_tr_b16 v[220:221], v211 offset:256
    v_cvt_pk_bf16_f32 v96, v40, v41
    v_mfma_f32_16x16x32_bf16 a[132:135], v[64:67], v[184:187], a[132:135]
    v_exp_f32 v43, v43
    v_mfma_f32_16x16x32_bf16 a[132:135], v[60:63], v[180:183], a[132:135]
    ds_read_b64_tr_b16 v[222:223], v211 offset:6400
    v_mfma_f32_16x16x32_bf16 a[116:119], v[60:63], v[172:175], a[116:119]
    ds_read_b64_tr_b16 v[224:225], v211 offset:12544
    v_mfma_f32_16x16x32_bf16 a[116:119], v[64:67], v[176:179], a[116:119]
    v_cvt_pk_bf16_f32 v97, v42, v43
    v_mfma_f32_16x16x32_bf16 a[100:103], v[64:67], v[168:171], a[100:103]
    buffer_load_dwordx4 v215, s[16:19], s27 offen offset:1024 lds
    v_mfma_f32_16x16x32_bf16 a[100:103], v[60:63], v[164:167], a[100:103]
    v_mfma_f32_16x16x32_bf16 a[104:107], v[68:71], v[164:167], a[104:107]
    v_exp_f32 v44, v44
    v_mfma_f32_16x16x32_bf16 a[104:107], v[72:75], v[168:171], a[104:107]
    ds_read_b64_tr_b16 v[226:227], v211 offset:18688
    v_mfma_f32_16x16x32_bf16 a[120:123], v[72:75], v[176:179], a[120:123]
    v_exp_f32 v45, v45
    v_mfma_f32_16x16x32_bf16 a[120:123], v[68:71], v[172:175], a[120:123]
    ds_read_b64_tr_b16 v[232:233], v212 offset:12544
    v_mfma_f32_16x16x32_bf16 a[136:139], v[68:71], v[180:183], a[136:139]
    v_exp_f32 v46, v46
    v_mfma_f32_16x16x32_bf16 a[136:139], v[72:75], v[184:187], a[136:139]
    ds_read_b64_tr_b16 v[234:235], v212 offset:18688
    v_cvt_pk_bf16_f32 v104, v44, v45
    v_mfma_f32_16x16x32_bf16 a[140:143], v[80:83], v[184:187], a[140:143]
    v_exp_f32 v47, v47
    v_mfma_f32_16x16x32_bf16 a[140:143], v[76:79], v[180:183], a[140:143]
    ds_read_b64_tr_b16 v[228:229], v212 offset:256
    v_mfma_f32_16x16x32_bf16 a[124:127], v[76:79], v[172:175], a[124:127]
    ds_read_b64_tr_b16 v[230:231], v212 offset:6400
    v_mfma_f32_16x16x32_bf16 a[124:127], v[80:83], v[176:179], a[124:127]
    v_cvt_pk_bf16_f32 v105, v46, v47
    v_mfma_f32_16x16x32_bf16 a[108:111], v[80:83], v[168:171], a[108:111]
    buffer_load_dwordx4 v216, s[16:19], s27 offen offset:2048 lds
    v_mfma_f32_16x16x32_bf16 a[108:111], v[76:79], v[164:167], a[108:111]
    v_mfma_f32_16x16x32_bf16 v[36:39], v[140:143], a[192:195], v[188:191]
    s_mov_b32 s36, s30
    v_exp_f32 v48, v48
    v_mfma_f32_16x16x32_bf16 v[36:39], v[144:147], a[196:199], v[36:39]
    s_add_u32 s34, s34, 1
    ds_read_b64_tr_b16 v[236:237], v213 offset:256
    v_mfma_f32_16x16x32_bf16 v[36:39], v[148:151], a[200:203], v[36:39]
    s_cmp_eq_u32 s34, 3
    v_exp_f32 v49, v49
    v_mfma_f32_16x16x32_bf16 v[36:39], v[152:155], a[204:207], v[36:39]
    s_waitcnt lgkmcnt(1)
    s_cselect_b32 s30, -49152, s37
    ds_read_b64_tr_b16 v[238:239], v213 offset:6400
    v_mfma_f32_16x16x32_bf16 v[36:39], v[156:159], a[208:211], v[36:39]
    s_cselect_b32 s34, 0, s34
    v_exp_f32 v50, v50
    v_mfma_f32_16x16x32_bf16 v[36:39], v[160:163], a[212:215], v[36:39]
    ds_read_b64_tr_b16 v[240:241], v213 offset:12544
    v_cvt_pk_bf16_f32 v112, v48, v49
    v_mfma_f32_16x16x32_bf16 v[40:43], v[160:163], a[236:239], v[192:195]
    v_exp_f32 v51, v51
    v_mfma_f32_16x16x32_bf16 v[40:43], v[156:159], a[232:235], v[40:43]
    ds_read_b64_tr_b16 v[242:243], v213 offset:18688
    v_mfma_f32_16x16x32_bf16 v[40:43], v[152:155], a[228:231], v[40:43]
    v_mfma_f32_16x16x32_bf16 v[40:43], v[148:151], a[224:227], v[40:43]
    v_cvt_pk_bf16_f32 v113, v50, v51
    v_mfma_f32_16x16x32_bf16 v[40:43], v[144:147], a[220:223], v[40:43]
    v_mfma_f32_16x16x32_bf16 v[40:43], v[140:143], a[216:219], v[40:43]
    v_mfma_f32_16x16x32_bf16 v[44:47], v[140:143], a[240:243], v[196:199]
    v_exp_f32 v36, v36
    v_mfma_f32_16x16x32_bf16 v[44:47], v[144:147], a[244:247], v[44:47]
    s_add_u32 s24, s24, 24576
    v_add_u32 v208, s30, v208
    v_mfma_f32_16x16x32_bf16 v[44:47], v[148:151], a[248:251], v[44:47]
    s_add_u32 s26, s26, 24576
    v_exp_f32 v37, v37
    v_mfma_f32_16x16x32_bf16 v[44:47], v[152:155], a[252:255], v[44:47]
    s_add_u32 s25, s25, 24576
    v_add_u32 v209, s30, v209
    v_mfma_f32_16x16x32_bf16 v[44:47], v[156:159], v[4:7], v[44:47]
    s_add_u32 s27, s27, 24576
    v_exp_f32 v38, v38
    v_mfma_f32_16x16x32_bf16 v[44:47], v[160:163], v[8:11], v[44:47]
    s_add_u32 s28, s28, s36
    v_cvt_pk_bf16_f32 v90, v36, v37
    v_add_u32 v210, s36, v210
    v_mfma_f32_16x16x32_bf16 v[48:51], v[160:163], v[32:35], v[200:203]
    s_add_u32 s29, s29, s38
    v_exp_f32 v39, v39
    v_mfma_f32_16x16x32_bf16 v[48:51], v[156:159], v[28:31], v[48:51]
    s_mov_b32 s38, s36
    v_add_u32 v211, s36, v211
    v_mfma_f32_16x16x32_bf16 v[48:51], v[152:155], v[24:27], v[48:51]
    v_add_u32 v212, s36, v212
    v_mfma_f32_16x16x32_bf16 v[48:51], v[148:151], v[20:23], v[48:51]
    v_cvt_pk_bf16_f32 v91, v38, v39
    v_add_u32 v213, s36, v213
    v_mfma_f32_16x16x32_bf16 v[48:51], v[144:147], v[16:19], v[48:51]
    s_waitcnt vmcnt(12) lgkmcnt(0)
    v_mfma_f32_16x16x32_bf16 v[48:51], v[140:143], v[12:15], v[48:51]
    s_barrier
    v_smfmac_f32_16x16x64_bf16 v[252:255], v[248:251], v[76:83], v218
    v_mfma_f32_16x16x32_bf16 a[144:147], v[52:55], v[220:223], a[144:147]
    v_exp_f32 v40, v40
    v_mfma_f32_16x16x32_bf16 a[144:147], v[56:59], v[224:227], a[144:147]
    ds_read_b128 v[116:119], v208 offset:0
    v_mfma_f32_16x16x32_bf16 a[160:163], v[56:59], v[232:235], a[160:163]
    v_exp_f32 v41, v41
    v_mfma_f32_16x16x32_bf16 a[160:163], v[52:55], v[228:231], a[160:163]
    ds_read_b128 v[120:123], v209 offset:0
    v_mfma_f32_16x16x32_bf16 a[176:179], v[52:55], v[236:239], a[176:179]
    v_exp_f32 v42, v42
    v_mfma_f32_16x16x32_bf16 a[176:179], v[56:59], v[240:243], a[176:179]
    ds_read_b128 v[124:127], v208 offset:128
    v_cvt_pk_bf16_f32 v98, v40, v41
    v_mfma_f32_16x16x32_bf16 a[180:183], v[64:67], v[240:243], a[180:183]
    v_exp_f32 v43, v43
    v_mfma_f32_16x16x32_bf16 a[180:183], v[60:63], v[236:239], a[180:183]
    ds_read_b64_tr_b16 v[164:165], v210 offset:0
    v_mfma_f32_16x16x32_bf16 a[164:167], v[60:63], v[228:231], a[164:167]
    ds_read_b64_tr_b16 v[166:167], v210 offset:6144
    v_mfma_f32_16x16x32_bf16 a[164:167], v[64:67], v[232:235], a[164:167]
    ds_read_b64_tr_b16 v[168:169], v210 offset:12288
    v_cvt_pk_bf16_f32 v99, v42, v43
    v_mfma_f32_16x16x32_bf16 a[148:151], v[64:67], v[224:227], a[148:151]
    v_mfma_f32_16x16x32_bf16 a[148:151], v[60:63], v[220:223], a[148:151]
    v_mfma_f32_16x16x32_bf16 a[152:155], v[68:71], v[220:223], a[152:155]
    v_exp_f32 v44, v44
    v_mfma_f32_16x16x32_bf16 a[152:155], v[72:75], v[224:227], a[152:155]
    ds_read_b128 v[128:131], v209 offset:128
    v_mfma_f32_16x16x32_bf16 a[168:171], v[72:75], v[232:235], a[168:171]
    v_exp_f32 v45, v45
    v_mfma_f32_16x16x32_bf16 a[168:171], v[68:71], v[228:231], a[168:171]
    ds_read_b128 v[132:135], v208 offset:256
    v_mfma_f32_16x16x32_bf16 a[184:187], v[68:71], v[236:239], a[184:187]
    v_exp_f32 v46, v46
    v_mfma_f32_16x16x32_bf16 a[184:187], v[72:75], v[240:243], a[184:187]
    ds_read_b128 v[136:139], v209 offset:256
    v_cvt_pk_bf16_f32 v106, v44, v45
    v_mfma_f32_16x16x32_bf16 a[188:191], v[80:83], v[240:243], a[188:191]
    v_exp_f32 v47, v47
    v_mfma_f32_16x16x32_bf16 a[188:191], v[76:79], v[236:239], a[188:191]
    ds_read_b64_tr_b16 v[170:171], v210 offset:18432
    v_mfma_f32_16x16x32_bf16 a[172:175], v[76:79], v[228:231], a[172:175]
    ds_read_b64_tr_b16 v[172:173], v211 offset:0
    v_mfma_f32_16x16x32_bf16 a[172:175], v[80:83], v[232:235], a[172:175]
    ds_read_b64_tr_b16 v[174:175], v211 offset:6144
    v_cvt_pk_bf16_f32 v107, v46, v47
    v_mfma_f32_16x16x32_bf16 a[156:159], v[80:83], v[224:227], a[156:159]
    v_mfma_f32_16x16x32_bf16 a[156:159], v[76:79], v[220:223], a[156:159]
    s_waitcnt lgkmcnt(4)
L_mid:
    v_mfma_f32_16x16x32_bf16 v[36:39], v[116:119], a[192:195], v[188:191]
    s_waitcnt lgkmcnt(10)
    v_exp_f32 v48, v48
    v_mfma_f32_16x16x32_bf16 v[36:39], v[120:123], a[196:199], v[36:39]
    s_waitcnt lgkmcnt(9)
    ds_read_b128 v[140:143], v208 offset:6144
    v_mfma_f32_16x16x32_bf16 v[36:39], v[124:127], a[200:203], v[36:39]
    s_waitcnt lgkmcnt(6)
    v_exp_f32 v49, v49
    v_mfma_f32_16x16x32_bf16 v[36:39], v[128:131], a[204:207], v[36:39]
    s_waitcnt lgkmcnt(5)
    ds_read_b128 v[144:147], v209 offset:6144
    v_mfma_f32_16x16x32_bf16 v[36:39], v[132:135], a[208:211], v[36:39]
    s_waitcnt lgkmcnt(2)
    v_exp_f32 v50, v50
    v_mfma_f32_16x16x32_bf16 v[36:39], v[136:139], a[212:215], v[36:39]
    ds_read_b64_tr_b16 v[176:177], v211 offset:12288
    v_cvt_pk_bf16_f32 v114, v48, v49
    v_mfma_f32_16x16x32_bf16 v[40:43], v[136:139], a[236:239], v[192:195]
    v_exp_f32 v51, v51
    v_mfma_f32_16x16x32_bf16 v[40:43], v[132:135], a[232:235], v[40:43]
    ds_read_b64_tr_b16 v[178:179], v211 offset:18432
    v_mfma_f32_16x16x32_bf16 v[40:43], v[128:131], a[228:231], v[40:43]
    ds_read_b64_tr_b16 v[180:181], v212 offset:0
    v_mfma_f32_16x16x32_bf16 v[40:43], v[124:127], a[224:227], v[40:43]
    s_mov_b32 m0, s28
    v_cvt_pk_bf16_f32 v115, v50, v51
    v_mfma_f32_16x16x32_bf16 v[40:43], v[120:123], a[220:223], v[40:43]
    buffer_load_dwordx4 v214, s[12:15], s24 offen offset:0 lds
    v_mfma_f32_16x16x32_bf16 v[40:43], v[116:119], a[216:219], v[40:43]
    v_mfma_f32_16x16x32_bf16 v[44:47], v[116:119], a[240:243], v[196:199]
    v_exp_f32 v36, v36
    v_mfma_f32_16x16x32_bf16 v[44:47], v[120:123], a[244:247], v[44:47]
    ds_read_b128 v[148:151], v208 offset:6272
    v_mfma_f32_16x16x32_bf16 v[44:47], v[124:127], a[248:251], v[44:47]
    v_exp_f32 v37, v37
    v_mfma_f32_16x16x32_bf16 v[44:47], v[128:131], a[252:255], v[44:47]
    ds_read_b128 v[152:155], v209 offset:6272
    v_mfma_f32_16x16x32_bf16 v[44:47], v[132:135], v[4:7], v[44:47]
    v_exp_f32 v38, v38
    v_mfma_f32_16x16x32_bf16 v[44:47], v[136:139], v[8:11], v[44:47]
    ds_read_b64_tr_b16 v[182:183], v212 offset:6144
    v_cvt_pk_bf16_f32 v52, v36, v37
    v_mfma_f32_16x16x32_bf16 v[48:51], v[136:139], v[32:35], v[200:203]
    v_exp_f32 v39, v39
    v_mfma_f32_16x16x32_bf16 v[48:51], v[132:135], v[28:31], v[48:51]
    ds_read_b64_tr_b16 v[184:185], v212 offset:12288
    v_mfma_f32_16x16x32_bf16 v[48:51], v[128:131], v[24:27], v[48:51]
    ds_read_b64_tr_b16 v[186:187], v212 offset:18432
    v_mfma_f32_16x16x32_bf16 v[48:51], v[124:127], v[20:23], v[48:51]
    v_cvt_pk_bf16_f32 v53, v38, v39
    v_mfma_f32_16x16x32_bf16 v[48:51], v[120:123], v[16:19], v[48:51]
    buffer_load_dwordx4 v215, s[12:15], s24 offen offset:1024 lds
    v_mfma_f32_16x16x32_bf16 v[48:51], v[116:119], v[12:15], v[48:51]
    v_smfmac_f32_16x16x64_bf16 v[204:207], v[244:247], v[84:91], v218
    v_mfma_f32_16x16x32_bf16 a[0:3], v[84:87], v[164:167], a[0:3]
    v_exp_f32 v40, v40
    v_mfma_f32_16x16x32_bf16 a[0:3], v[88:91], v[168:171], a[0:3]
    s_waitcnt lgkmcnt(1)
    ds_read_b128 v[156:159], v208 offset:6400
    v_mfma_f32_16x16x32_bf16 a[16:19], v[88:91], v[176:179], a[16:19]
    v_exp_f32 v41, v41
    v_mfma_f32_16x16x32_bf16 a[16:19], v[84:87], v[172:175], a[16:19]
    ds_read_b128 v[160:163], v209 offset:6400
    v_mfma_f32_16x16x32_bf16 a[32:35], v[84:87], v[180:183], a[32:35]
    s_waitcnt lgkmcnt(2)
    v_exp_f32 v42, v42
    v_mfma_f32_16x16x32_bf16 a[32:35], v[88:91], v[184:187], a[32:35]
    ds_read_b64_tr_b16 v[220:221], v213 offset:0
    v_cvt_pk_bf16_f32 v60, v40, v41
    v_mfma_f32_16x16x32_bf16 a[36:39], v[96:99], v[184:187], a[36:39]
    v_exp_f32 v43, v43
    v_mfma_f32_16x16x32_bf16 a[36:39], v[92:95], v[180:183], a[36:39]
    ds_read_b64_tr_b16 v[222:223], v213 offset:6144
    v_mfma_f32_16x16x32_bf16 a[20:23], v[92:95], v[172:175], a[20:23]
    ds_read_b64_tr_b16 v[224:225], v213 offset:12288
    v_mfma_f32_16x16x32_bf16 a[20:23], v[96:99], v[176:179], a[20:23]
    v_cvt_pk_bf16_f32 v61, v42, v43
    v_mfma_f32_16x16x32_bf16 a[4:7], v[96:99], v[168:171], a[4:7]
    buffer_load_dwordx4 v216, s[12:15], s24 offen offset:2048 lds
    v_mfma_f32_16x16x32_bf16 a[4:7], v[92:95], v[164:167], a[4:7]
    v_mfma_f32_16x16x32_bf16 a[8:11], v[100:103], v[164:167], a[8:11]
    v_exp_f32 v44, v44
    v_mfma_f32_16x16x32_bf16 a[8:11], v[104:107], v[168:171], a[8:11]
    ds_read_b64_tr_b16 v[226:227], v213 offset:18432
    v_mfma_f32_16x16x32_bf16 a[24:27], v[104:107], v[176:179], a[24:27]
    v_exp_f32 v45, v45
    v_mfma_f32_16x16x32_bf16 a[24:27], v[100:103], v[172:175], a[24:27]
    ds_read_b64_tr_b16 v[232:233], v210 offset:12416
    v_mfma_f32_16x16x32_bf16 a[40:43], v[100:103], v[180:183], a[40:43]
    v_exp_f32 v46, v46
    v_mfma_f32_16x16x32_bf16 a[40:43], v[104:107], v[184:187], a[40:43]
    ds_read_b64_tr_b16 v[234:235], v210 offset:18560
    v_cvt_pk_bf16_f32 v68, v44, v45
    v_mfma_f32_16x16x32_bf16 a[44:47], v[112:115], v[184:187], a[44:47]
    v_exp_f32 v47, v47
    v_mfma_f32_16x16x32_bf16 a[44:47], v[108:111], v[180:183], a[44:47]
    ds_read_b64_tr_b16 v[228:229], v210 offset:128
    v_mfma_f32_16x16x32_bf16 a[28:31], v[108:111], v[172:175], a[28:31]
    ds_read_b64_tr_b16 v[230:231], v210 offset:6272
    v_mfma_f32_16x16x32_bf16 a[28:31], v[112:115], v[176:179], a[28:31]
    s_add_u32 m0, s28, 3072
    v_cvt_pk_bf16_f32 v69, v46, v47
    v_mfma_f32_16x16x32_bf16 a[12:15], v[112:115], v[168:171], a[12:15]
    buffer_load_dwordx4 v214, s[12:15], s26 offen offset:0 lds
    v_mfma_f32_16x16x32_bf16 a[12:15], v[108:111], v[164:167], a[12:15]
    v_mfma_f32_16x16x32_bf16 v[36:39], v[140:143], a[192:195], v[188:191]
    v_exp_f32 v48, v48
    v_mfma_f32_16x16x32_bf16 v[36:39], v[144:147], a[196:199], v[36:39]
    ds_read_b128 v[116:119], v208 offset:12288
    v_mfma_f32_16x16x32_bf16 v[36:39], v[148:151], a[200:203], v[36:39]
    v_exp_f32 v49, v49
    v_mfma_f32_16x16x32_bf16 v[36:39], v[152:155], a[204:207], v[36:39]
    s_waitcnt lgkmcnt(1)
    ds_read_b128 v[120:123], v209 offset:12288
    v_mfma_f32_16x16x32_bf16 v[36:39], v[156:159], a[208:211], v[36:39]
    v_exp_f32 v50, v50
    v_mfma_f32_16x16x32_bf16 v[36:39], v[160:163], a[212:215], v[36:39]
    ds_read_b64_tr_b16 v[236:237], v211 offset:128
    v_cvt_pk_bf16_f32 v76, v48, v49
    v_mfma_f32_16x16x32_bf16 v[40:43], v[160:163], a[236:239], v[192:195]
    v_exp_f32 v51, v51
    v_mfma_f32_16x16x32_bf16 v[40:43], v[156:159], a[232:235], v[40:43]
    ds_read_b64_tr_b16 v[238:239], v211 offset:6272
    v_mfma_f32_16x16x32_bf16 v[40:43], v[152:155], a[228:231], v[40:43]
    ds_read_b64_tr_b16 v[240:241], v211 offset:12416
    v_mfma_f32_16x16x32_bf16 v[40:43], v[148:151], a[224:227], v[40:43]
    v_cvt_pk_bf16_f32 v77, v50, v51
    v_mfma_f32_16x16x32_bf16 v[40:43], v[144:147], a[220:223], v[40:43]
    buffer_load_dwordx4 v215, s[12:15], s26 offen offset:1024 lds
    v_mfma_f32_16x16x32_bf16 v[40:43], v[140:143], a[216:219], v[40:43]
    v_mfma_f32_16x16x32_bf16 v[44:47], v[140:143], a[240:243], v[196:199]
    v_exp_f32 v36, v36
    v_mfma_f32_16x16x32_bf16 v[44:47], v[144:147], a[244:247], v[44:47]
    ds_read_b128 v[124:127], v208 offset:12416
    v_mfma_f32_16x16x32_bf16 v[44:47], v[148:151], a[248:251], v[44:47]
    v_exp_f32 v37, v37
    v_mfma_f32_16x16x32_bf16 v[44:47], v[152:155], a[252:255], v[44:47]
    ds_read_b128 v[128:131], v209 offset:12416
    v_mfma_f32_16x16x32_bf16 v[44:47], v[156:159], v[4:7], v[44:47]
    v_exp_f32 v38, v38
    v_mfma_f32_16x16x32_bf16 v[44:47], v[160:163], v[8:11], v[44:47]
    ds_read_b64_tr_b16 v[242:243], v211 offset:18560
    v_cvt_pk_bf16_f32 v54, v36, v37
    v_mfma_f32_16x16x32_bf16 v[48:51], v[160:163], v[32:35], v[200:203]
    v_exp_f32 v39, v39
    v_mfma_f32_16x16x32_bf16 v[48:51], v[156:159], v[28:31], v[48:51]
    v_mfma_f32_16x16x32_bf16 v[48:51], v[152:155], v[24:27], v[48:51]
    v_mfma_f32_16x16x32_bf16 v[48:51], v[148:151], v[20:23], v[48:51]
    v_cvt_pk_bf16_f32 v55, v38, v39
    v_mfma_f32_16x16x32_bf16 v[48:51], v[144:147], v[16:19], v[48:51]
    buffer_load_dwordx4 v216, s[12:15], s26 offen offset:2048 lds
    v_mfma_f32_16x16x32_bf16 v[48:51], v[140:143], v[12:15], v[48:51]
    v_smfmac_f32_16x16x64_bf16 v[204:207], v[248:251], v[92:99], v218
    v_mfma_f32_16x16x32_bf16 a[48:51], v[84:87], v[220:223], a[48:51]
    v_exp_f32 v40, v40
    v_mfma_f32_16x16x32_bf16 a[48:51], v[88:91], v[224:227], a[48:51]
    ds_read_b128 v[132:135], v208 offset:12544
    v_mfma_f32_16x16x32_bf16 a[64:67], v[88:91], v[232:235], a[64:67]
    v_exp_f32 v41, v41
    v_mfma_f32_16x16x32_bf16 a[64:67], v[84:87], v[228:231], a[64:67]
    s_waitcnt lgkmcnt(1)
    ds_read_b128 v[136:139], v209 offset:12544
    v_mfma_f32_16x16x32_bf16 a[80:83], v[84:87], v[236:239], a[80:83]
    v_exp_f32 v42, v42
    v_mfma_f32_16x16x32_bf16 a[80:83], v[88:91], v[240:243], a[80:83]
    ds_read_b64_tr_b16 v[164:165], v212 offset:128
    v_cvt_pk_bf16_f32 v62, v40, v41
    v_mfma_f32_16x16x32_bf16 a[84:87], v[96:99], v[240:243], a[84:87]
    v_exp_f32 v43, v43
    v_mfma_f32_16x16x32_bf16 a[84:87], v[92:95], v[236:239], a[84:87]
    ds_read_b64_tr_b16 v[166:167], v212 offset:6272
    v_mfma_f32_16x16x32_bf16 a[68:71], v[92:95], v[228:231], a[68:71]
    ds_read_b64_tr_b16 v[168:169], v212 offset:12416
    v_mfma_f32_16x16x32_bf16 a[68:71], v[96:99], v[232:235], a[68:71]
    s_mov_b32 m0, s29
    v_cvt_pk_bf16_f32 v63, v42, v43
    v_mfma_f32_16x16x32_bf16 a[52:55], v[96:99], v[224:227], a[52:55]
    buffer_load_dwordx4 v214, s[16:19], s25 offen offset:0 lds
    v_mfma_f32_16x16x32_bf16 a[52:55], v[92:95], v[220:223], a[52:55]
    v_mfma_f32_16x16x32_bf16 a[56:59], v[100:103], v[220:223], a[56:59]
    v_exp_f32 v44, v44
    v_mfma_f32_16x16x32_bf16 a[56:59], v[104:107], v[224:227], a[56:59]
    ds_read_b64_tr_b16 v[170:171], v212 offset:18560
    v_mfma_f32_16x16x32_bf16 a[72:75], v[104:107], v[232:235], a[72:75]
    v_exp_f32 v45, v45
    v_mfma_f32_16x16x32_bf16 a[72:75], v[100:103], v[228:231], a[72:75]
    ds_read_b64_tr_b16 v[176:177], v213 offset:12416
    v_mfma_f32_16x16x32_bf16 a[88:91], v[100:103], v[236:239], a[88:91]
    v_exp_f32 v46, v46
    v_mfma_f32_16x16x32_bf16 a[88:91], v[104:107], v[240:243], a[88:91]
    ds_read_b64_tr_b16 v[178:179], v213 offset:18560
    v_cvt_pk_bf16_f32 v70, v44, v45
    v_mfma_f32_16x16x32_bf16 a[92:95], v[112:115], v[240:243], a[92:95]
    v_exp_f32 v47, v47
    v_mfma_f32_16x16x32_bf16 a[92:95], v[108:111], v[236:239], a[92:95]
    ds_read_b64_tr_b16 v[172:173], v213 offset:128
    v_mfma_f32_16x16x32_bf16 a[76:79], v[108:111], v[228:231], a[76:79]
    ds_read_b64_tr_b16 v[174:175], v213 offset:6272
    v_mfma_f32_16x16x32_bf16 a[76:79], v[112:115], v[232:235], a[76:79]
    v_cvt_pk_bf16_f32 v71, v46, v47
    v_mfma_f32_16x16x32_bf16 a[60:63], v[112:115], v[224:227], a[60:63]
    buffer_load_dwordx4 v215, s[16:19], s25 offen offset:1024 lds
    v_mfma_f32_16x16x32_bf16 a[60:63], v[108:111], v[220:223], a[60:63]
    v_mfma_f32_16x16x32_bf16 v[36:39], v[116:119], a[192:195], v[188:191]
    v_exp_f32 v48, v48
    v_mfma_f32_16x16x32_bf16 v[36:39], v[120:123], a[196:199], v[36:39]
    ds_read_b128 v[140:143], v208 offset:18432
    v_mfma_f32_16x16x32_bf16 v[36:39], v[124:127], a[200:203], v[36:39]
    v_exp_f32 v49, v49
    v_mfma_f32_16x16x32_bf16 v[36:39], v[128:131], a[204:207], v[36:39]
    s_waitcnt lgkmcnt(1)
    ds_read_b128 v[144:147], v209 offset:18432
    v_mfma_f32_16x16x32_bf16 v[36:39], v[132:135], a[208:211], v[36:39]
    v_exp_f32 v50, v50
    v_mfma_f32_16x16x32_bf16 v[36:39], v[136:139], a[212:215], v[36:39]
    ds_read_b64_tr_b16 v[180:181], v210 offset:256
    v_cvt_pk_bf16_f32 v78, v48, v49
    v_mfma_f32_16x16x32_bf16 v[40:43], v[136:139], a[236:239], v[192:195]
    v_exp_f32 v51, v51
    v_mfma_f32_16x16x32_bf16 v[40:43], v[132:135], a[232:235], v[40:43]
    ds_read_b64_tr_b16 v[182:183], v210 offset:6400
    v_mfma_f32_16x16x32_bf16 v[40:43], v[128:131], a[228:231], v[40:43]
    ds_read_b64_tr_b16 v[184:185], v210 offset:12544
    v_mfma_f32_16x16x32_bf16 v[40:43], v[124:127], a[224:227], v[40:43]
    v_cvt_pk_bf16_f32 v79, v50, v51
    v_mfma_f32_16x16x32_bf16 v[40:43], v[120:123], a[220:223], v[40:43]
    buffer_load_dwordx4 v216, s[16:19], s25 offen offset:2048 lds
    v_mfma_f32_16x16x32_bf16 v[40:43], v[116:119], a[216:219], v[40:43]
    v_mfma_f32_16x16x32_bf16 v[44:47], v[116:119], a[240:243], v[196:199]
    v_exp_f32 v36, v36
    v_mfma_f32_16x16x32_bf16 v[44:47], v[120:123], a[244:247], v[44:47]
    ds_read_b128 v[148:151], v208 offset:18560
    v_mfma_f32_16x16x32_bf16 v[44:47], v[124:127], a[248:251], v[44:47]
    v_exp_f32 v37, v37
    v_mfma_f32_16x16x32_bf16 v[44:47], v[128:131], a[252:255], v[44:47]
    ds_read_b128 v[152:155], v209 offset:18560
    v_mfma_f32_16x16x32_bf16 v[44:47], v[132:135], v[4:7], v[44:47]
    v_exp_f32 v38, v38
    v_mfma_f32_16x16x32_bf16 v[44:47], v[136:139], v[8:11], v[44:47]
    ds_read_b64_tr_b16 v[186:187], v210 offset:18688
    v_cvt_pk_bf16_f32 v56, v36, v37
    v_mfma_f32_16x16x32_bf16 v[48:51], v[136:139], v[32:35], v[200:203]
    v_exp_f32 v39, v39
    v_mfma_f32_16x16x32_bf16 v[48:51], v[132:135], v[28:31], v[48:51]
    v_mfma_f32_16x16x32_bf16 v[48:51], v[128:131], v[24:27], v[48:51]
    v_mfma_f32_16x16x32_bf16 v[48:51], v[124:127], v[20:23], v[48:51]
    s_add_u32 m0, s29, 3072
    v_cvt_pk_bf16_f32 v57, v38, v39
    v_mfma_f32_16x16x32_bf16 v[48:51], v[120:123], v[16:19], v[48:51]
    buffer_load_dwordx4 v214, s[16:19], s27 offen offset:0 lds
    v_mfma_f32_16x16x32_bf16 v[48:51], v[116:119], v[12:15], v[48:51]
    v_smfmac_f32_16x16x64_bf16 v[252:255], v[244:247], v[100:107], v218
    v_mfma_f32_16x16x32_bf16 a[96:99], v[84:87], v[164:167], a[96:99]
    v_exp_f32 v40, v40
    v_mfma_f32_16x16x32_bf16 a[96:99], v[88:91], v[168:171], a[96:99]
    ds_read_b128 v[156:159], v208 offset:18688
    v_mfma_f32_16x16x32_bf16 a[112:115], v[88:91], v[176:179], a[112:115]
    v_exp_f32 v41, v41
    v_mfma_f32_16x16x32_bf16 a[112:115], v[84:87], v[172:175], a[112:115]
    s_waitcnt lgkmcnt(1)
    ds_read_b128 v[160:163], v209 offset:18688
    v_mfma_f32_16x16x32_bf16 a[128:131], v[84:87], v[180:183], a[128:131]
    v_exp_f32 v42, v42
    v_mfma_f32_16x16x32_bf16 a[128:131], v[88:91], v[184:187], a[128:131]
    ds_read_b64_tr_b16 v[220:221], v211 offset:256
    v_cvt_pk_bf16_f32 v64, v40, v41
    v_mfma_f32_16x16x32_bf16 a[132:135], v[96:99], v[184:187], a[132:135]
    v_exp_f32 v43, v43
    v_mfma_f32_16x16x32_bf16 a[132:135], v[92:95], v[180:183], a[132:135]
    ds_read_b64_tr_b16 v[222:223], v211 offset:6400
    v_mfma_f32_16x16x32_bf16 a[116:119], v[92:95], v[172:175], a[116:119]
    ds_read_b64_tr_b16 v[224:225], v211 offset:12544
    v_mfma_f32_16x16x32_bf16 a[116:119], v[96:99], v[176:179], a[116:119]
    v_cvt_pk_bf16_f32 v65, v42, v43
    v_mfma_f32_16x16x32_bf16 a[100:103], v[96:99], v[168:171], a[100:103]
    buffer_load_dwordx4 v215, s[16:19], s27 offen offset:1024 lds
    v_mfma_f32_16x16x32_bf16 a[100:103], v[92:95], v[164:167], a[100:103]
    v_mfma_f32_16x16x32_bf16 a[104:107], v[100:103], v[164:167], a[104:107]
    v_exp_f32 v44, v44
    v_mfma_f32_16x16x32_bf16 a[104:107], v[104:107], v[168:171], a[104:107]
    ds_read_b64_tr_b16 v[226:227], v211 offset:18688
    v_mfma_f32_16x16x32_bf16 a[120:123], v[104:107], v[176:179], a[120:123]
    v_exp_f32 v45, v45
    v_mfma_f32_16x16x32_bf16 a[120:123], v[100:103], v[172:175], a[120:123]
    ds_read_b64_tr_b16 v[232:233], v212 offset:12544
    v_mfma_f32_16x16x32_bf16 a[136:139], v[100:103], v[180:183], a[136:139]
    v_exp_f32 v46, v46
    v_mfma_f32_16x16x32_bf16 a[136:139], v[104:107], v[184:187], a[136:139]
    ds_read_b64_tr_b16 v[234:235], v212 offset:18688
    v_cvt_pk_bf16_f32 v72, v44, v45
    v_mfma_f32_16x16x32_bf16 a[140:143], v[112:115], v[184:187], a[140:143]
    v_exp_f32 v47, v47
    v_mfma_f32_16x16x32_bf16 a[140:143], v[108:111], v[180:183], a[140:143]
    ds_read_b64_tr_b16 v[228:229], v212 offset:256
    v_mfma_f32_16x16x32_bf16 a[124:127], v[108:111], v[172:175], a[124:127]
    ds_read_b64_tr_b16 v[230:231], v212 offset:6400
    v_mfma_f32_16x16x32_bf16 a[124:127], v[112:115], v[176:179], a[124:127]
    v_cvt_pk_bf16_f32 v73, v46, v47
    v_mfma_f32_16x16x32_bf16 a[108:111], v[112:115], v[168:171], a[108:111]
    buffer_load_dwordx4 v216, s[16:19], s27 offen offset:2048 lds
    v_mfma_f32_16x16x32_bf16 a[108:111], v[108:111], v[164:167], a[108:111]
    v_mfma_f32_16x16x32_bf16 v[36:39], v[140:143], a[192:195], v[188:191]
    s_mov_b32 s36, s30
    v_exp_f32 v48, v48
    v_mfma_f32_16x16x32_bf16 v[36:39], v[144:147], a[196:199], v[36:39]
    s_add_u32 s34, s34, 1
    ds_read_b64_tr_b16 v[236:237], v213 offset:256
    v_mfma_f32_16x16x32_bf16 v[36:39], v[148:151], a[200:203], v[36:39]
    s_cmp_eq_u32 s34, 3
    v_exp_f32 v49, v49
    v_mfma_f32_16x16x32_bf16 v[36:39], v[152:155], a[204:207], v[36:39]
    s_waitcnt lgkmcnt(1)
    s_cselect_b32 s30, -49152, s37
    ds_read_b64_tr_b16 v[238:239], v213 offset:6400
    v_mfma_f32_16x16x32_bf16 v[36:39], v[156:159], a[208:211], v[36:39]
    s_cselect_b32 s34, 0, s34
    v_exp_f32 v50, v50
    v_mfma_f32_16x16x32_bf16 v[36:39], v[160:163], a[212:215], v[36:39]
    ds_read_b64_tr_b16 v[240:241], v213 offset:12544
    v_cvt_pk_bf16_f32 v80, v48, v49
    v_mfma_f32_16x16x32_bf16 v[40:43], v[160:163], a[236:239], v[192:195]
    v_exp_f32 v51, v51
    v_mfma_f32_16x16x32_bf16 v[40:43], v[156:159], a[232:235], v[40:43]
    ds_read_b64_tr_b16 v[242:243], v213 offset:18688
    v_mfma_f32_16x16x32_bf16 v[40:43], v[152:155], a[228:231], v[40:43]
    v_mfma_f32_16x16x32_bf16 v[40:43], v[148:151], a[224:227], v[40:43]
    v_cvt_pk_bf16_f32 v81, v50, v51
    v_mfma_f32_16x16x32_bf16 v[40:43], v[144:147], a[220:223], v[40:43]
    v_mfma_f32_16x16x32_bf16 v[40:43], v[140:143], a[216:219], v[40:43]
    v_mfma_f32_16x16x32_bf16 v[44:47], v[140:143], a[240:243], v[196:199]
    v_exp_f32 v36, v36
    v_mfma_f32_16x16x32_bf16 v[44:47], v[144:147], a[244:247], v[44:47]
    s_add_u32 s24, s24, 24576
    v_add_u32 v208, s30, v208
    v_mfma_f32_16x16x32_bf16 v[44:47], v[148:151], a[248:251], v[44:47]
    s_add_u32 s26, s26, 24576
    v_exp_f32 v37, v37
    v_mfma_f32_16x16x32_bf16 v[44:47], v[152:155], a[252:255], v[44:47]
    s_add_u32 s25, s25, 24576
    v_add_u32 v209, s30, v209
    v_mfma_f32_16x16x32_bf16 v[44:47], v[156:159], v[4:7], v[44:47]
    s_add_u32 s27, s27, 24576
    v_exp_f32 v38, v38
    v_mfma_f32_16x16x32_bf16 v[44:47], v[160:163], v[8:11], v[44:47]
    s_add_u32 s28, s28, s36
    v_cvt_pk_bf16_f32 v58, v36, v37
    v_add_u32 v210, s36, v210
    v_mfma_f32_16x16x32_bf16 v[48:51], v[160:163], v[32:35], v[200:203]
    s_add_u32 s29, s29, s38
    v_exp_f32 v39, v39
    v_mfma_f32_16x16x32_bf16 v[48:51], v[156:159], v[28:31], v[48:51]
    s_mov_b32 s38, s36
    v_add_u32 v211, s36, v211
    v_mfma_f32_16x16x32_bf16 v[48:51], v[152:155], v[24:27], v[48:51]
    v_add_u32 v212, s36, v212
    v_mfma_f32_16x16x32_bf16 v[48:51], v[148:151], v[20:23], v[48:51]
    v_cvt_pk_bf16_f32 v59, v38, v39
    v_add_u32 v213, s36, v213
    v_mfma_f32_16x16x32_bf16 v[48:51], v[144:147], v[16:19], v[48:51]
    s_waitcnt vmcnt(12) lgkmcnt(0)
    v_mfma_f32_16x16x32_bf16 v[48:51], v[140:143], v[12:15], v[48:51]
    s_barrier
    v_smfmac_f32_16x16x64_bf16 v[252:255], v[248:251], v[108:115], v218
    v_mfma_f32_16x16x32_bf16 a[144:147], v[84:87], v[220:223], a[144:147]
    v_exp_f32 v40, v40
    v_mfma_f32_16x16x32_bf16 a[144:147], v[88:91], v[224:227], a[144:147]
    ds_read_b128 v[116:119], v208 offset:0
    v_mfma_f32_16x16x32_bf16 a[160:163], v[88:91], v[232:235], a[160:163]
    v_exp_f32 v41, v41
    v_mfma_f32_16x16x32_bf16 a[160:163], v[84:87], v[228:231], a[160:163]
    ds_read_b128 v[120:123], v209 offset:0
    v_mfma_f32_16x16x32_bf16 a[176:179], v[84:87], v[236:239], a[176:179]
    v_exp_f32 v42, v42
    v_mfma_f32_16x16x32_bf16 a[176:179], v[88:91], v[240:243], a[176:179]
    ds_read_b128 v[124:127], v208 offset:128
    v_cvt_pk_bf16_f32 v66, v40, v41
    v_mfma_f32_16x16x32_bf16 a[180:183], v[96:99], v[240:243], a[180:183]
    v_exp_f32 v43, v43
    v_mfma_f32_16x16x32_bf16 a[180:183], v[92:95], v[236:239], a[180:183]
    ds_read_b64_tr_b16 v[164:165], v210 offset:0
    v_mfma_f32_16x16x32_bf16 a[164:167], v[92:95], v[228:231], a[164:167]
    ds_read_b64_tr_b16 v[166:167], v210 offset:6144
    v_mfma_f32_16x16x32_bf16 a[164:167], v[96:99], v[232:235], a[164:167]
    ds_read_b64_tr_b16 v[168:169], v210 offset:12288
    v_cvt_pk_bf16_f32 v67, v42, v43
    v_mfma_f32_16x16x32_bf16 a[148:151], v[96:99], v[224:227], a[148:151]
    v_mfma_f32_16x16x32_bf16 a[148:151], v[92:95], v[220:223], a[148:151]
    v_mfma_f32_16x16x32_bf16 a[152:155], v[100:103], v[220:223], a[152:155]
    v_exp_f32 v44, v44
    v_mfma_f32_16x16x32_bf16 a[152:155], v[104:107], v[224:227], a[152:155]
    ds_read_b128 v[128:131], v209 offset:128
    v_mfma_f32_16x16x32_bf16 a[168:171], v[104:107], v[232:235], a[168:171]
    v_exp_f32 v45, v45
    v_mfma_f32_16x16x32_bf16 a[168:171], v[100:103], v[228:231], a[168:171]
    ds_read_b128 v[132:135], v208 offset:256
    v_mfma_f32_16x16x32_bf16 a[184:187], v[100:103], v[236:239], a[184:187]
    v_exp_f32 v46, v46
    v_mfma_f32_16x16x32_bf16 a[184:187], v[104:107], v[240:243], a[184:187]
    ds_read_b128 v[136:139], v209 offset:256
    v_cvt_pk_bf16_f32 v74, v44, v45
    v_mfma_f32_16x16x32_bf16 a[188:191], v[112:115], v[240:243], a[188:191]
    v_exp_f32 v47, v47
    v_mfma_f32_16x16x32_bf16 a[188:191], v[108:111], v[236:239], a[188:191]
    ds_read_b64_tr_b16 v[170:171], v210 offset:18432
    v_mfma_f32_16x16x32_bf16 a[172:175], v[108:111], v[228:231], a[172:175]
    s_sub_u32 s31, s31, 1
    ds_read_b64_tr_b16 v[172:173], v211 offset:0
    v_mfma_f32_16x16x32_bf16 a[172:175], v[112:115], v[232:235], a[172:175]
    s_cmp_lg_u32 s31, 0
    ds_read_b64_tr_b16 v[174:175], v211 offset:6144
    v_cvt_pk_bf16_f32 v75, v46, v47
    v_mfma_f32_16x16x32_bf16 a[156:159], v[112:115], v[224:227], a[156:159]
    v_mfma_f32_16x16x32_bf16 a[156:159], v[108:111], v[220:223], a[156:159]
    s_waitcnt lgkmcnt(4)
    s_cbranch_scc1 L_loop
L_tail:
    s_lshl_b32 s39, s33, 11
    s_add_u32 s39, s39, 148736
    s_add_u32 s61, s60, 24576
    s_mov_b32 s38, 1088
    s_mov_b32 m0, s29
    v_mfma_f32_16x16x32_bf16 v[36:39], v[116:119], a[240:243], v[196:199]
    buffer_load_dwordx4 v214, s[16:19], s25 offen offset:0 lds
    v_mfma_f32_16x16x32_bf16 v[36:39], v[120:123], a[244:247], v[36:39]
    v_exp_f32 v48, v48
    v_mfma_f32_16x16x32_bf16 v[36:39], v[124:127], a[248:251], v[36:39]
    buffer_load_dwordx4 v215, s[16:19], s25 offen offset:1024 lds
    v_mfma_f32_16x16x32_bf16 v[36:39], v[128:131], a[252:255], v[36:39]
    v_exp_f32 v49, v49
    v_mfma_f32_16x16x32_bf16 v[36:39], v[132:135], v[4:7], v[36:39]
    s_waitcnt lgkmcnt(3)
    buffer_load_dwordx4 v216, s[16:19], s25 offen offset:2048 lds
    s_add_u32 m0, s29, 3072
    v_mfma_f32_16x16x32_bf16 v[36:39], v[136:139], v[8:11], v[36:39]
    ds_read_b64_tr_b16 v[176:177], v211 offset:12288
    v_cvt_pk_bf16_f32 v82, v48, v49
    v_mfma_f32_16x16x32_bf16 a[0:3], v[52:55], v[164:167], a[0:3]
    s_waitcnt lgkmcnt(3)
    buffer_load_dwordx4 v214, s[16:19], s27 offen offset:0 lds
    v_mfma_f32_16x16x32_bf16 a[0:3], v[56:59], v[168:171], a[0:3]
    v_exp_f32 v50, v50
    v_mfma_f32_16x16x32_bf16 a[4:7], v[64:67], v[168:171], a[4:7]
    buffer_load_dwordx4 v215, s[16:19], s27 offen offset:1024 lds
    v_mfma_f32_16x16x32_bf16 a[4:7], v[60:63], v[164:167], a[4:7]
    v_exp_f32 v51, v51
    v_mfma_f32_16x16x32_bf16 a[8:11], v[68:71], v[164:167], a[8:11]
    ds_read_b64_tr_b16 v[178:179], v211 offset:18432
    v_cvt_pk_bf16_f32 v83, v50, v51
    v_mfma_f32_16x16x32_bf16 a[8:11], v[72:75], v[168:171], a[8:11]
    buffer_load_dwordx4 v216, s[16:19], s27 offen offset:2048 lds
    v_mfma_f32_16x16x32_bf16 a[12:15], v[80:83], v[168:171], a[12:15]
    v_exp_f32 v36, v36
    v_mfma_f32_16x16x32_bf16 a[12:15], v[76:79], v[164:167], a[12:15]
    v_exp_f32 v37, v37
    v_smfmac_f32_16x16x64_bf16 v[204:207], v[244:247], v[52:59], v218
    ds_read_b64_tr_b16 v[180:181], v212 offset:0
    v_cvt_pk_bf16_f32 v100, v36, v37
    v_smfmac_f32_16x16x64_bf16 v[204:207], v[248:251], v[60:67], v218
    v_exp_f32 v38, v38
    v_smfmac_f32_16x16x64_bf16 v[252:255], v[244:247], v[68:75], v218
    v_exp_f32 v39, v39
    v_smfmac_f32_16x16x64_bf16 v[252:255], v[248:251], v[76:83], v218
    s_waitcnt lgkmcnt(3)
    ds_read_b64_tr_b16 v[182:183], v212 offset:6144
    v_cvt_pk_bf16_f32 v101, v38, v39
    v_mfma_f32_16x16x32_bf16 a[16:19], v[52:55], v[172:175], a[16:19]
    s_waitcnt lgkmcnt(2)
    ds_read_b64_tr_b16 v[184:185], v212 offset:12288
    v_mbcnt_lo_u32_b32 v236, -1, 0
    v_mfma_f32_16x16x32_bf16 a[16:19], v[56:59], v[176:179], a[16:19]
    ds_read_b64_tr_b16 v[186:187], v212 offset:18432
    v_mbcnt_hi_u32_b32 v236, -1, v236
    v_mfma_f32_16x16x32_bf16 a[20:23], v[64:67], v[176:179], a[20:23]
    ds_read_b128 v[140:143], v208 offset:6144
    v_and_b32 v237, 15, v236
    v_mfma_f32_16x16x32_bf16 a[20:23], v[60:63], v[172:175], a[20:23]
    ds_read_b128 v[144:147], v209 offset:6144
    v_lshrrev_b32 v188, 4, v236
    v_mfma_f32_16x16x32_bf16 v[40:43], v[116:119], v[12:15], v[200:203]
    ds_read_b128 v[148:151], v208 offset:6272
    v_lshl_add_u32 v242, v236, 2, s39
    v_mfma_f32_16x16x32_bf16 v[40:43], v[120:123], v[16:19], v[40:43]
    ds_read_b128 v[152:155], v209 offset:6272
    v_lshl_add_u32 v238, v237, 2, s61
    v_mfma_f32_16x16x32_bf16 v[40:43], v[124:127], v[20:23], v[40:43]
    ds_read_b128 v[156:159], v208 offset:6400
    v_mad_u32_u24 v238, v188, s38, v238
    v_mfma_f32_16x16x32_bf16 v[40:43], v[128:131], v[24:27], v[40:43]
    ds_read_b128 v[160:163], v209 offset:6400
    v_lshrrev_b32 v188, 3, v236
    v_mfma_f32_16x16x32_bf16 v[40:43], v[132:135], v[28:31], v[40:43]
    ds_read_b64_tr_b16 v[164:165], v213 offset:0
    v_and_b32 v237, 7, v236
    v_mfma_f32_16x16x32_bf16 v[40:43], v[136:139], v[32:35], v[40:43]
    ds_read_b64_tr_b16 v[166:167], v213 offset:6144
    v_lshl_add_u32 v243, v188, 2, s39
    v_mfma_f32_16x16x32_bf16 a[24:27], v[68:71], v[172:175], a[24:27]
    ds_read_b64_tr_b16 v[168:169], v213 offset:12288
    v_lshl_add_u32 v239, v237, 5, s61
    v_mfma_f32_16x16x32_bf16 a[24:27], v[72:75], v[176:179], a[24:27]
    ds_read_b64_tr_b16 v[170:171], v213 offset:18432
    v_and_b32 v237, 8, v236
    v_mfma_f32_16x16x32_bf16 a[28:31], v[80:83], v[176:179], a[28:31]
    v_exp_f32 v40, v40
    v_mfma_f32_16x16x32_bf16 a[28:31], v[76:79], v[172:175], a[28:31]
    s_waitcnt lgkmcnt(12)
    v_exp_f32 v41, v41
    v_mfma_f32_16x16x32_bf16 a[32:35], v[52:55], v[180:183], a[32:35]
    s_waitcnt lgkmcnt(10)
    ds_read_b64_tr_b16 v[172:173], v210 offset:128
    v_cvt_pk_bf16_f32 v108, v40, v41
    v_mfma_f32_16x16x32_bf16 a[32:35], v[56:59], v[184:187], a[32:35]
    v_exp_f32 v42, v42
    v_mfma_f32_16x16x32_bf16 a[36:39], v[64:67], v[184:187], a[36:39]
    v_exp_f32 v43, v43
    v_mfma_f32_16x16x32_bf16 a[36:39], v[60:63], v[180:183], a[36:39]
    ds_read_b64_tr_b16 v[174:175], v210 offset:6272
    v_cvt_pk_bf16_f32 v109, v42, v43
    v_mfma_f32_16x16x32_bf16 a[40:43], v[68:71], v[180:183], a[40:43]
    ds_read_b64_tr_b16 v[176:177], v210 offset:12416
    v_mul_u32_u24 v237, 66, v237
    v_mfma_f32_16x16x32_bf16 a[40:43], v[72:75], v[184:187], a[40:43]
    ds_read_b64_tr_b16 v[178:179], v210 offset:18560
    v_and_b32 v188, 16, v236
    v_mfma_f32_16x16x32_bf16 a[44:47], v[80:83], v[184:187], a[44:47]
    v_lshl_add_u32 v237, v188, 4, v237
    v_and_b32 v188, 32, v236
    v_mfma_f32_16x16x32_bf16 a[44:47], v[76:79], v[180:183], a[44:47]
    s_waitcnt lgkmcnt(13)
    ds_read_b64_tr_b16 v[180:181], v211 offset:128
    v_add_f32 v204, v204, v205
    v_mfma_f32_16x16x32_bf16 v[44:47], v[140:143], a[240:243], v[196:199]
    s_waitcnt lgkmcnt(13)
    v_rcp_f32 v236, v204
    v_mfma_f32_16x16x32_bf16 v[44:47], v[144:147], a[244:247], v[44:47]
    s_waitcnt lgkmcnt(12)
    ds_read_b64_tr_b16 v[182:183], v211 offset:6272
    v_mul_u32_u24 v188, 34, v188
    v_mfma_f32_16x16x32_bf16 v[44:47], v[148:151], a[248:251], v[44:47]
    s_waitcnt lgkmcnt(12)
    ds_read_b64_tr_b16 v[184:185], v211 offset:12416
    v_add3_u32 v239, v188, v237, v239
    v_mfma_f32_16x16x32_bf16 v[44:47], v[152:155], a[252:255], v[44:47]
    s_waitcnt lgkmcnt(12)
    ds_read_b64_tr_b16 v[186:187], v211 offset:18560
    v_add_f32 v206, v206, v207
    v_mfma_f32_16x16x32_bf16 v[44:47], v[156:159], v[4:7], v[44:47]
    s_waitcnt lgkmcnt(12)
    v_rcp_f32 v237, v206
    v_mfma_f32_16x16x32_bf16 v[44:47], v[160:163], v[8:11], v[44:47]
    s_waitcnt lgkmcnt(10)
    ds_read_b128 v[116:119], v208 offset:12288
    v_add_u32 v240, 24576, v238
    v_mfma_f32_16x16x32_bf16 a[48:51], v[52:55], v[164:167], a[48:51]
    s_waitcnt lgkmcnt(9)
    ds_read_b128 v[120:123], v209 offset:12288
    v_add_u32 v241, 24576, v239
    v_mfma_f32_16x16x32_bf16 a[48:51], v[56:59], v[168:171], a[48:51]
    ds_write_b32 v242, v236 offset:0
    v_mfma_f32_16x16x32_bf16 a[52:55], v[64:67], v[168:171], a[52:55]
    ds_read2_b32 v[188:189], v243 offset0:0 offset1:8
    v_exp_f32 v44, v44
    v_mfma_f32_16x16x32_bf16 a[52:55], v[60:63], v[164:167], a[52:55]
    ds_write_b32 v242, v237 offset:256
    v_mfma_f32_16x16x32_bf16 a[56:59], v[68:71], v[164:167], a[56:59]
    ds_read2_b32 v[190:191], v243 offset0:64 offset1:72
    v_exp_f32 v45, v45
    v_mfma_f32_16x16x32_bf16 a[56:59], v[72:75], v[168:171], a[56:59]
    ds_write2_b32 v238, a0, a1 offset0:0 offset1:132
    v_mfma_f32_16x16x32_bf16 a[60:63], v[80:83], v[168:171], a[60:63]
    ds_read_b128 v[124:127], v208 offset:12416
    v_cvt_pk_bf16_f32 v102, v44, v45
    v_mfma_f32_16x16x32_bf16 a[60:63], v[76:79], v[164:167], a[60:63]
    s_waitcnt lgkmcnt(14)
    ds_write2_b32 v238, a2, a3 offset0:64 offset1:196
    v_mfma_f32_16x16x32_bf16 a[64:67], v[52:55], v[172:175], a[64:67]
    s_waitcnt lgkmcnt(13)
    v_exp_f32 v46, v46
    v_mfma_f32_16x16x32_bf16 a[64:67], v[56:59], v[176:179], a[64:67]
    ds_write2_b32 v238, a16, a17 offset0:16 offset1:148
    v_mfma_f32_16x16x32_bf16 a[68:71], v[64:67], v[176:179], a[68:71]
    v_exp_f32 v47, v47
    v_mfma_f32_16x16x32_bf16 a[68:71], v[60:63], v[172:175], a[68:71]
    ds_write2_b32 v238, a18, a19 offset0:80 offset1:212
    v_mfma_f32_16x16x32_bf16 v[48:51], v[140:143], v[12:15], v[200:203]
    ds_read_b128 v[128:131], v209 offset:12416
    v_cvt_pk_bf16_f32 v103, v46, v47
    v_mfma_f32_16x16x32_bf16 v[48:51], v[144:147], v[16:19], v[48:51]
    ds_write2_b32 v238, a32, a33 offset0:32 offset1:164
    v_mfma_f32_16x16x32_bf16 v[48:51], v[148:151], v[20:23], v[48:51]
    ds_read_b128 v[132:135], v208 offset:12544
    v_mfma_f32_16x16x32_bf16 v[48:51], v[152:155], v[24:27], v[48:51]
    ds_write2_b32 v238, a34, a35 offset0:96 offset1:228
    v_mfma_f32_16x16x32_bf16 v[48:51], v[156:159], v[28:31], v[48:51]
    ds_read_b128 v[136:139], v209 offset:12544
    v_mfma_f32_16x16x32_bf16 v[48:51], v[160:163], v[32:35], v[48:51]
    ds_write2_b32 v238, a48, a49 offset0:48 offset1:180
    v_mfma_f32_16x16x32_bf16 a[72:75], v[68:71], v[172:175], a[72:75]
    ds_read_b64_tr_b16 v[164:165], v212 offset:128
    v_mfma_f32_16x16x32_bf16 a[72:75], v[72:75], v[176:179], a[72:75]
    ds_write2_b32 v238, a50, a51 offset0:112 offset1:244
    v_mfma_f32_16x16x32_bf16 a[76:79], v[80:83], v[176:179], a[76:79]
    ds_read_b128 v[220:223], v239 offset:0
    s_nop 0
    v_exp_f32 v48, v48
    v_mfma_f32_16x16x32_bf16 a[76:79], v[76:79], v[172:175], a[76:79]
    s_waitcnt lgkmcnt(15)
    v_exp_f32 v49, v49
    v_mfma_f32_16x16x32_bf16 a[80:83], v[52:55], v[180:183], a[80:83]
    ds_read_b64_tr_b16 v[166:167], v212 offset:6272
    v_cvt_pk_bf16_f32 v110, v48, v49
    v_mfma_f32_16x16x32_bf16 a[80:83], v[56:59], v[184:187], a[80:83]
    v_exp_f32 v50, v50
    v_mfma_f32_16x16x32_bf16 a[84:87], v[64:67], v[184:187], a[84:87]
    ds_read_b128 v[224:227], v239 offset:16
    v_exp_f32 v51, v51
    v_mfma_f32_16x16x32_bf16 a[84:87], v[60:63], v[180:183], a[84:87]
    ds_read_b128 v[228:231], v239 offset:2176
    v_cvt_pk_bf16_f32 v111, v50, v51
    v_mfma_f32_16x16x32_bf16 a[88:91], v[68:71], v[180:183], a[88:91]
    s_waitcnt lgkmcnt(3)
    s_waitcnt vmcnt(0)
    ds_read_b128 v[232:235], v239 offset:2192
    v_mul_f32 v220, v220, v188
    v_mfma_f32_16x16x32_bf16 a[88:91], v[72:75], v[184:187], a[88:91]
    ds_write2_b32 v238, a4, a5 offset0:0 offset1:132
    v_mul_f32 v221, v221, v188
    v_mfma_f32_16x16x32_bf16 a[92:95], v[80:83], v[184:187], a[92:95]
    ds_read_b64_tr_b16 v[168:169], v212 offset:12416
    v_cvt_pk_bf16_f32 v220, v220, v221
    v_mfma_f32_16x16x32_bf16 a[92:95], v[76:79], v[180:183], a[92:95]
    ds_write2_b32 v238, a6, a7 offset0:64 offset1:196
    v_mul_f32 v222, v222, v188
    v_mfma_f32_16x16x32_bf16 v[36:39], v[116:119], a[240:243], v[196:199]
    ds_read_b64_tr_b16 v[170:171], v212 offset:18560
    v_mul_f32 v223, v223, v188
    v_mfma_f32_16x16x32_bf16 v[36:39], v[120:123], a[244:247], v[36:39]
    ds_write2_b32 v238, a20, a21 offset0:16 offset1:148
    v_cvt_pk_bf16_f32 v221, v222, v223
    v_mfma_f32_16x16x32_bf16 v[36:39], v[124:127], a[248:251], v[36:39]
    s_waitcnt lgkmcnt(7)
    ds_read_b64_tr_b16 v[172:173], v213 offset:128
    v_mul_f32 v224, v224, v188
    v_mfma_f32_16x16x32_bf16 v[36:39], v[128:131], a[252:255], v[36:39]
    ds_write2_b32 v238, a22, a23 offset0:80 offset1:212
    v_mul_f32 v225, v225, v188
    v_mfma_f32_16x16x32_bf16 v[36:39], v[132:135], v[4:7], v[36:39]
    ds_read_b64_tr_b16 v[174:175], v213 offset:6272
    v_cvt_pk_bf16_f32 v222, v224, v225
    v_mfma_f32_16x16x32_bf16 v[36:39], v[136:139], v[8:11], v[36:39]
    ds_write2_b32 v238, a36, a37 offset0:32 offset1:164
    v_mul_f32 v226, v226, v188
    v_mfma_f32_16x16x32_bf16 a[96:99], v[52:55], v[164:167], a[96:99]
    s_waitcnt lgkmcnt(5)
    ds_read_b64_tr_b16 v[176:177], v213 offset:12416
    v_mul_f32 v227, v227, v188
    v_mfma_f32_16x16x32_bf16 a[96:99], v[56:59], v[168:171], a[96:99]
    ds_write2_b32 v238, a38, a39 offset0:96 offset1:228
    v_cvt_pk_bf16_f32 v223, v226, v227
    v_mul_f32 v228, v228, v189
    v_mfma_f32_16x16x32_bf16 a[100:103], v[64:67], v[168:171], a[100:103]
    ds_read_b64_tr_b16 v[178:179], v213 offset:18560
    buffer_store_dwordx4 v[220:223], v217, s[20:23], 0 offen offset:0 sc1
    v_mul_f32 v229, v229, v189
    v_mfma_f32_16x16x32_bf16 a[100:103], v[60:63], v[164:167], a[100:103]
    ds_write2_b32 v238, a52, a53 offset0:48 offset1:180
    v_cvt_pk_bf16_f32 v228, v228, v229
    v_mfma_f32_16x16x32_bf16 a[104:107], v[68:71], v[164:167], a[104:107]
    ds_read_b64_tr_b16 v[180:181], v210 offset:256
    v_mul_f32 v230, v230, v189
    v_mfma_f32_16x16x32_bf16 a[104:107], v[72:75], v[168:171], a[104:107]
    ds_write2_b32 v238, a54, a55 offset0:112 offset1:244
    v_mul_f32 v231, v231, v189
    v_mfma_f32_16x16x32_bf16 a[108:111], v[80:83], v[168:171], a[108:111]
    ds_read_b128 v[84:87], v239 offset:0
    v_cvt_pk_bf16_f32 v229, v230, v231
    v_mfma_f32_16x16x32_bf16 a[108:111], v[76:79], v[164:167], a[108:111]
    s_waitcnt lgkmcnt(8)
    ds_read_b64_tr_b16 v[182:183], v210 offset:6400
    v_mul_f32 v232, v232, v189
    v_mfma_f32_16x16x32_bf16 a[112:115], v[52:55], v[172:175], a[112:115]
    s_waitcnt lgkmcnt(5)
    ds_read_b64_tr_b16 v[184:185], v210 offset:12544
    v_mul_f32 v233, v233, v189
    v_mfma_f32_16x16x32_bf16 a[112:115], v[56:59], v[176:179], a[112:115]
    ds_read_b64_tr_b16 v[186:187], v210 offset:18688
    v_cvt_pk_bf16_f32 v230, v232, v233
    v_mfma_f32_16x16x32_bf16 a[116:119], v[64:67], v[176:179], a[116:119]
    ds_read_b128 v[88:91], v239 offset:16
    v_mul_f32 v234, v234, v189
    v_mfma_f32_16x16x32_bf16 a[116:119], v[60:63], v[172:175], a[116:119]
    ds_read_b128 v[92:95], v239 offset:2176
    v_mul_f32 v235, v235, v189
    v_mfma_f32_16x16x32_bf16 v[40:43], v[116:119], v[12:15], v[200:203]
    s_waitcnt lgkmcnt(5)
    ds_read_b128 v[96:99], v239 offset:2192
    v_cvt_pk_bf16_f32 v231, v234, v235
    v_mul_f32 v84, v84, v190
    v_mfma_f32_16x16x32_bf16 v[40:43], v[120:123], v[16:19], v[40:43]
    ds_write2_b32 v238, a64, a65 offset0:0 offset1:132
    buffer_store_dwordx4 v[228:231], v217, s[20:23], 0 offen offset:3072 sc1
    v_mul_f32 v85, v85, v190
    v_mfma_f32_16x16x32_bf16 v[40:43], v[124:127], v[20:23], v[40:43]
    ds_read_b128 v[140:143], v208 offset:18432
    v_cvt_pk_bf16_f32 v84, v84, v85
    v_mfma_f32_16x16x32_bf16 v[40:43], v[128:131], v[24:27], v[40:43]
    ds_write2_b32 v238, a66, a67 offset0:64 offset1:196
    v_mul_f32 v86, v86, v190
    v_mfma_f32_16x16x32_bf16 v[40:43], v[132:135], v[28:31], v[40:43]
    ds_read_b128 v[144:147], v209 offset:18432
    v_mul_f32 v87, v87, v190
    v_mfma_f32_16x16x32_bf16 v[40:43], v[136:139], v[32:35], v[40:43]
    ds_write2_b32 v238, a80, a81 offset0:16 offset1:148
    v_cvt_pk_bf16_f32 v85, v86, v87
    v_mfma_f32_16x16x32_bf16 a[120:123], v[68:71], v[172:175], a[120:123]
    s_waitcnt lgkmcnt(7)
    ds_read_b128 v[148:151], v208 offset:18560
    v_mul_f32 v88, v88, v190
    v_mfma_f32_16x16x32_bf16 a[120:123], v[72:75], v[176:179], a[120:123]
    ds_write2_b32 v238, a82, a83 offset0:80 offset1:212
    v_mul_f32 v89, v89, v190
    v_mfma_f32_16x16x32_bf16 a[124:127], v[80:83], v[176:179], a[124:127]
    ds_read_b128 v[152:155], v209 offset:18560
    v_cvt_pk_bf16_f32 v86, v88, v89
    v_mfma_f32_16x16x32_bf16 a[124:127], v[76:79], v[172:175], a[124:127]
    ds_write2_b32 v238, a96, a97 offset0:32 offset1:164
    v_mul_f32 v90, v90, v190
    v_mfma_f32_16x16x32_bf16 a[128:131], v[52:55], v[180:183], a[128:131]
    ds_read_b128 v[156:159], v208 offset:18688
    v_mul_f32 v91, v91, v190
    v_mfma_f32_16x16x32_bf16 a[128:131], v[56:59], v[184:187], a[128:131]
    s_waitcnt lgkmcnt(11)
    ds_write2_b32 v238, a98, a99 offset0:96 offset1:228
    v_cvt_pk_bf16_f32 v87, v90, v91
    v_mul_f32 v92, v92, v191
    v_mfma_f32_16x16x32_bf16 a[132:135], v[64:67], v[184:187], a[132:135]
    buffer_store_dwordx4 v[84:87], v217, s[20:23], s45 offen offset:0 sc1
    v_mul_f32 v93, v93, v191
    v_mfma_f32_16x16x32_bf16 a[132:135], v[60:63], v[180:183], a[132:135]
    ds_write2_b32 v238, a112, a113 offset0:48 offset1:180
    v_cvt_pk_bf16_f32 v92, v92, v93
    v_mfma_f32_16x16x32_bf16 a[136:139], v[68:71], v[180:183], a[136:139]
    ds_read_b128 v[160:163], v209 offset:18688
    v_mul_f32 v94, v94, v191
    v_mfma_f32_16x16x32_bf16 a[136:139], v[72:75], v[184:187], a[136:139]
    ds_read_b64_tr_b16 v[164:165], v211 offset:256
    ds_write2_b32 v238, a114, a115 offset0:112 offset1:244
    v_mul_f32 v95, v95, v191
    v_mfma_f32_16x16x32_bf16 a[140:143], v[80:83], v[184:187], a[140:143]
    ds_read_b64_tr_b16 v[166:167], v211 offset:6400
    ds_read_b128 v[220:223], v239 offset:0
    v_cvt_pk_bf16_f32 v93, v94, v95
    v_mfma_f32_16x16x32_bf16 a[140:143], v[76:79], v[180:183], a[140:143]
    s_waitcnt lgkmcnt(15)
    ds_read_b64_tr_b16 v[168:169], v211 offset:12544
    v_mul_f32 v96, v96, v191
    v_mfma_f32_16x16x32_bf16 v[44:47], v[140:143], a[240:243], v[196:199]
    s_waitcnt lgkmcnt(14)
    ds_read_b64_tr_b16 v[170:171], v211 offset:18688
    ds_read_b128 v[224:227], v239 offset:16
    v_mul_f32 v97, v97, v191
    v_mfma_f32_16x16x32_bf16 v[44:47], v[144:147], a[244:247], v[44:47]
    s_waitcnt lgkmcnt(14)
    ds_read_b128 v[228:231], v239 offset:2176
    v_cvt_pk_bf16_f32 v94, v96, v97
    v_mfma_f32_16x16x32_bf16 v[44:47], v[148:151], a[248:251], v[44:47]
    s_waitcnt lgkmcnt(13)
    ds_read_b128 v[232:235], v239 offset:2192
    v_mul_f32 v98, v98, v191
    v_mfma_f32_16x16x32_bf16 v[44:47], v[152:155], a[252:255], v[44:47]
    s_waitcnt lgkmcnt(12)
    ds_write2_b32 v238, a68, a69 offset0:0 offset1:132
    v_mul_f32 v99, v99, v191
    v_mfma_f32_16x16x32_bf16 v[44:47], v[156:159], v[4:7], v[44:47]
    s_waitcnt lgkmcnt(6)
    v_cvt_pk_bf16_f32 v95, v98, v99
    v_mul_f32 v220, v220, v188
    v_mfma_f32_16x16x32_bf16 v[44:47], v[160:163], v[8:11], v[44:47]
    ds_read_b64_tr_b16 v[172:173], v212 offset:256
    buffer_store_dwordx4 v[92:95], v217, s[20:23], s45 offen offset:3072 sc1
    ds_write2_b32 v238, a70, a71 offset0:64 offset1:196
    v_mul_f32 v221, v221, v188
    v_mfma_f32_16x16x32_bf16 a[144:147], v[52:55], v[164:167], a[144:147]
    s_waitcnt lgkmcnt(6)
    ds_read_b64_tr_b16 v[174:175], v212 offset:6400
    v_cvt_pk_bf16_f32 v220, v220, v221
    v_mfma_f32_16x16x32_bf16 a[144:147], v[56:59], v[168:171], a[144:147]
    ds_read_b64_tr_b16 v[176:177], v212 offset:12544
    ds_write2_b32 v238, a84, a85 offset0:16 offset1:148
    v_mul_f32 v222, v222, v188
    v_mfma_f32_16x16x32_bf16 a[148:151], v[64:67], v[168:171], a[148:151]
    ds_read_b64_tr_b16 v[178:179], v212 offset:18688
    v_mul_f32 v223, v223, v188
    v_mfma_f32_16x16x32_bf16 a[148:151], v[60:63], v[164:167], a[148:151]
    ds_write2_b32 v238, a86, a87 offset0:80 offset1:212
    v_cvt_pk_bf16_f32 v221, v222, v223
    v_mfma_f32_16x16x32_bf16 a[152:155], v[68:71], v[164:167], a[152:155]
    s_waitcnt lgkmcnt(10)
    ds_read_b64_tr_b16 v[180:181], v213 offset:256
    v_mul_f32 v224, v224, v188
    v_mfma_f32_16x16x32_bf16 a[152:155], v[72:75], v[168:171], a[152:155]
    ds_write2_b32 v238, a100, a101 offset0:32 offset1:164
    v_mul_f32 v225, v225, v188
    v_mfma_f32_16x16x32_bf16 a[156:159], v[80:83], v[168:171], a[156:159]
    ds_read_b64_tr_b16 v[182:183], v213 offset:6400
    v_cvt_pk_bf16_f32 v222, v224, v225
    v_mfma_f32_16x16x32_bf16 a[156:159], v[76:79], v[164:167], a[156:159]
    s_waitcnt lgkmcnt(7)
    ds_write2_b32 v238, a102, a103 offset0:96 offset1:228
    v_mul_f32 v226, v226, v188
    v_mfma_f32_16x16x32_bf16 a[160:163], v[52:55], v[172:175], a[160:163]
    s_waitcnt lgkmcnt(5)
    ds_read_b64_tr_b16 v[184:185], v213 offset:12544
    v_mul_f32 v227, v227, v188
    v_mfma_f32_16x16x32_bf16 a[160:163], v[56:59], v[176:179], a[160:163]
    ds_write2_b32 v238, a116, a117 offset0:48 offset1:180
    v_cvt_pk_bf16_f32 v223, v226, v227
    v_mul_f32 v228, v228, v189
    v_mfma_f32_16x16x32_bf16 a[164:167], v[64:67], v[176:179], a[164:167]
    buffer_store_dwordx4 v[220:223], v217, s[20:23], 0 offen offset:128 sc1
    v_mul_f32 v229, v229, v189
    v_mfma_f32_16x16x32_bf16 a[164:167], v[60:63], v[172:175], a[164:167]
    ds_write2_b32 v238, a118, a119 offset0:112 offset1:244
    v_cvt_pk_bf16_f32 v228, v228, v229
    v_mfma_f32_16x16x32_bf16 v[48:51], v[140:143], v[12:15], v[200:203]
    ds_read_b128 v[84:87], v239 offset:0
    v_mul_f32 v230, v230, v189
    v_mfma_f32_16x16x32_bf16 v[48:51], v[144:147], v[16:19], v[48:51]
    ds_read_b128 v[88:91], v239 offset:16
    v_mul_f32 v231, v231, v189
    v_mfma_f32_16x16x32_bf16 v[48:51], v[148:151], v[20:23], v[48:51]
    ds_read_b128 v[92:95], v239 offset:2176
    v_cvt_pk_bf16_f32 v229, v230, v231
    v_mfma_f32_16x16x32_bf16 v[48:51], v[152:155], v[24:27], v[48:51]
    ds_read_b128 v[96:99], v239 offset:2192
    v_mul_f32 v232, v232, v189
    v_mfma_f32_16x16x32_bf16 v[48:51], v[156:159], v[28:31], v[48:51]
    ds_read_b64_tr_b16 v[186:187], v213 offset:18688
    v_mul_f32 v233, v233, v189
    ds_write2_b32 v238, a128, a129 offset0:0 offset1:132
    v_mfma_f32_16x16x32_bf16 v[48:51], v[160:163], v[32:35], v[48:51]
    v_cvt_pk_bf16_f32 v230, v232, v233
    v_add_u32 v208, -49152, v208
    v_mfma_f32_16x16x32_bf16 a[168:171], v[68:71], v[172:175], a[168:171]
    ds_write2_b32 v238, a130, a131 offset0:64 offset1:196
    v_mul_f32 v234, v234, v189
    v_mfma_f32_16x16x32_bf16 a[168:171], v[72:75], v[176:179], a[168:171]
    v_mul_f32 v235, v235, v189
    v_add_u32 v209, -49152, v209
    v_mfma_f32_16x16x32_bf16 a[172:175], v[80:83], v[176:179], a[172:175]
    s_waitcnt lgkmcnt(0)
    s_barrier
    ds_read_b128 v[116:119], v208 offset:0
    v_cvt_pk_bf16_f32 v231, v234, v235
    ds_write2_b32 v238, a144, a145 offset0:16 offset1:148
    v_mul_f32 v84, v84, v190
    v_mfma_f32_16x16x32_bf16 a[172:175], v[76:79], v[172:175], a[172:175]
    ds_read_b128 v[120:123], v209 offset:0
    buffer_store_dwordx4 v[228:231], v217, s[20:23], 0 offen offset:3200 sc1
    v_mul_f32 v85, v85, v190
    v_mfma_f32_16x16x32_bf16 a[176:179], v[52:55], v[180:183], a[176:179]
    ds_read_b128 v[124:127], v208 offset:128
    ds_write2_b32 v238, a146, a147 offset0:80 offset1:212
    v_cvt_pk_bf16_f32 v84, v84, v85
    v_mfma_f32_16x16x32_bf16 a[176:179], v[56:59], v[184:187], a[176:179]
    v_exp_f32 v36, v36
    v_add_u32 v210, 24576, v210
    ds_read_b64_tr_b16 v[164:165], v210 offset:0
    v_mul_f32 v86, v86, v190
    v_mfma_f32_16x16x32_bf16 a[180:183], v[64:67], v[184:187], a[180:183]
    ds_read_b64_tr_b16 v[166:167], v210 offset:6144
    v_exp_f32 v37, v37
    ds_write2_b32 v238, a160, a161 offset0:32 offset1:164
    v_mul_f32 v87, v87, v190
    v_mfma_f32_16x16x32_bf16 a[180:183], v[60:63], v[180:183], a[180:183]
    ds_read_b64_tr_b16 v[168:169], v210 offset:12288
    v_exp_f32 v38, v38
    v_cvt_pk_bf16_f32 v85, v86, v87
    v_mfma_f32_16x16x32_bf16 a[184:187], v[68:71], v[180:183], a[184:187]
    ds_read_b128 v[128:131], v209 offset:128
    v_exp_f32 v39, v39
    ds_write2_b32 v238, a162, a163 offset0:96 offset1:228
    v_mul_f32 v88, v88, v190
    v_mfma_f32_16x16x32_bf16 a[184:187], v[72:75], v[184:187], a[184:187]
    ds_read_b128 v[132:135], v208 offset:256
    v_exp_f32 v40, v40
    v_mul_f32 v89, v89, v190
    v_mfma_f32_16x16x32_bf16 a[188:191], v[80:83], v[184:187], a[188:191]
    ds_read_b128 v[136:139], v209 offset:256
    v_cvt_pk_bf16_f32 v104, v36, v37
    v_cvt_pk_bf16_f32 v105, v38, v39
    v_exp_f32 v41, v41
    ds_write2_b32 v238, a176, a177 offset0:48 offset1:180
    v_cvt_pk_bf16_f32 v86, v88, v89
    v_mfma_f32_16x16x32_bf16 a[188:191], v[76:79], v[180:183], a[188:191]
    s_waitcnt lgkmcnt(13)
    v_exp_f32 v42, v42
    v_mul_f32 v90, v90, v190
    v_mfma_f32_16x16x32_bf16 v[36:39], v[116:119], a[240:243], v[196:199]
    s_waitcnt lgkmcnt(11)
    ds_read_b64_tr_b16 v[170:171], v210 offset:18432
    v_exp_f32 v43, v43
    ds_write2_b32 v238, a178, a179 offset0:112 offset1:244
    v_mul_f32 v91, v91, v190
    v_mfma_f32_16x16x32_bf16 v[36:39], v[120:123], a[244:247], v[36:39]
    s_waitcnt lgkmcnt(12)
    ds_read_b128 v[52:55], v239 offset:0
    v_exp_f32 v44, v44
    v_cvt_pk_bf16_f32 v87, v90, v91
    v_mul_f32 v92, v92, v191
    v_mfma_f32_16x16x32_bf16 v[36:39], v[124:127], a[248:251], v[36:39]
    s_waitcnt lgkmcnt(7)
    ds_read_b128 v[56:59], v239 offset:16
    v_exp_f32 v45, v45
    buffer_store_dwordx4 v[84:87], v217, s[20:23], s45 offen offset:128 sc1
    v_mul_f32 v93, v93, v191
    v_mfma_f32_16x16x32_bf16 v[36:39], v[128:131], a[252:255], v[36:39]
    s_waitcnt lgkmcnt(6)
    ds_read_b128 v[60:63], v239 offset:2176
    v_exp_f32 v46, v46
    v_cvt_pk_bf16_f32 v92, v92, v93
    v_mfma_f32_16x16x32_bf16 v[36:39], v[132:135], v[4:7], v[36:39]
    s_waitcnt lgkmcnt(6)
    ds_read_b128 v[64:67], v239 offset:2192
    v_exp_f32 v47, v47
    v_mul_f32 v94, v94, v191
    v_mfma_f32_16x16x32_bf16 v[36:39], v[136:139], v[8:11], v[36:39]
    ds_write2_b32 v238, a132, a133 offset0:0 offset1:132
    v_cvt_pk_bf16_f32 v106, v44, v45
    v_cvt_pk_bf16_f32 v107, v46, v47
    v_mul_f32 v95, v95, v191
    v_mfma_f32_16x16x32_bf16 a[8:11], v[100:103], v[164:167], a[8:11]
    s_waitcnt lgkmcnt(6)
    v_cvt_pk_bf16_f32 v112, v40, v41
    v_cvt_pk_bf16_f32 v113, v42, v43
    v_cvt_pk_bf16_f32 v93, v94, v95
    v_mfma_f32_16x16x32_bf16 a[8:11], v[104:107], v[168:171], a[8:11]
    v_add_u32 v211, 24576, v211
    ds_read_b64_tr_b16 v[172:173], v211 offset:0
    v_mul_f32 v96, v96, v191
    ds_write2_b32 v238, a134, a135 offset0:64 offset1:196
    v_mfma_f32_16x16x32_bf16 v[40:43], v[116:119], v[12:15], v[200:203]
    ds_read_b64_tr_b16 v[174:175], v211 offset:6144
    v_exp_f32 v48, v48
    v_mul_f32 v97, v97, v191
    v_mfma_f32_16x16x32_bf16 v[40:43], v[120:123], v[16:19], v[40:43]
    ds_read_b128 v[140:143], v208 offset:6144
    v_exp_f32 v49, v49
    v_cvt_pk_bf16_f32 v94, v96, v97
    ds_write2_b32 v238, a148, a149 offset0:16 offset1:148
    v_mfma_f32_16x16x32_bf16 v[40:43], v[124:127], v[20:23], v[40:43]
    ds_read_b128 v[144:147], v209 offset:6144
    v_exp_f32 v50, v50
    v_mul_f32 v98, v98, v191
    v_mfma_f32_16x16x32_bf16 v[40:43], v[128:131], v[24:27], v[40:43]
    ds_read_b128 v[148:151], v208 offset:6272
    v_exp_f32 v51, v51
    v_mul_f32 v99, v99, v191
    ds_write2_b32 v238, a150, a151 offset0:80 offset1:212
    v_mfma_f32_16x16x32_bf16 v[40:43], v[132:135], v[28:31], v[40:43]
    s_waitcnt lgkmcnt(12)
    ds_read_b128 v[152:155], v209 offset:6272
    v_cvt_pk_bf16_f32 v114, v48, v49
    v_cvt_pk_bf16_f32 v115, v50, v51
    v_cvt_pk_bf16_f32 v95, v98, v99
    v_mul_f32 v52, v52, v188
    v_mfma_f32_16x16x32_bf16 v[40:43], v[136:139], v[32:35], v[40:43]
    ds_read_b128 v[156:159], v208 offset:6400
    buffer_store_dwordx4 v[92:95], v217, s[20:23], s45 offen offset:3200 sc1
    ds_write2_b32 v238, a164, a165 offset0:32 offset1:164
    v_mul_f32 v53, v53, v188
    v_mfma_f32_16x16x32_bf16 a[12:15], v[112:115], v[168:171], a[12:15]
    ds_read_b128 v[160:163], v209 offset:6400
    v_cvt_pk_bf16_f32 v52, v52, v53
    v_mfma_f32_16x16x32_bf16 a[12:15], v[108:111], v[164:167], a[12:15]
    s_waitcnt lgkmcnt(8)
    ds_read_b64_tr_b16 v[176:177], v211 offset:12288
    ds_write2_b32 v238, a166, a167 offset0:96 offset1:228
    v_mul_f32 v54, v54, v188
    v_mfma_f32_16x16x32_bf16 v[44:47], v[140:143], a[240:243], v[196:199]
    s_waitcnt lgkmcnt(8)
    ds_read_b64_tr_b16 v[178:179], v211 offset:18432
    v_mul_f32 v55, v55, v188
    v_mfma_f32_16x16x32_bf16 v[44:47], v[144:147], a[244:247], v[44:47]
    s_waitcnt lgkmcnt(8)
    ds_write2_b32 v238, a180, a181 offset0:48 offset1:180
    v_cvt_pk_bf16_f32 v53, v54, v55
    v_mfma_f32_16x16x32_bf16 v[44:47], v[148:151], a[248:251], v[44:47]
    s_waitcnt lgkmcnt(7)
    ds_read_b128 v[116:119], v208 offset:12288
    v_mul_f32 v56, v56, v188
    v_mfma_f32_16x16x32_bf16 v[44:47], v[152:155], a[252:255], v[44:47]
    s_waitcnt lgkmcnt(7)
    ds_write2_b32 v238, a182, a183 offset0:112 offset1:244
    v_mul_f32 v57, v57, v188
    v_mfma_f32_16x16x32_bf16 v[44:47], v[156:159], v[4:7], v[44:47]
    s_waitcnt lgkmcnt(6)
    ds_read_b128 v[220:223], v239 offset:0
    v_cvt_pk_bf16_f32 v54, v56, v57
    v_mfma_f32_16x16x32_bf16 v[44:47], v[160:163], v[8:11], v[44:47]
    ds_read_b128 v[224:227], v239 offset:16
    v_mul_f32 v58, v58, v188
    v_mfma_f32_16x16x32_bf16 a[24:27], v[100:103], v[172:175], a[24:27]
    s_waitcnt lgkmcnt(5)
    ds_read_b128 v[228:231], v239 offset:2176
    v_mul_f32 v59, v59, v188
    v_mfma_f32_16x16x32_bf16 a[24:27], v[104:107], v[176:179], a[24:27]
    ds_read_b128 v[232:235], v239 offset:2192
    v_cvt_pk_bf16_f32 v55, v58, v59
    v_mul_f32 v60, v60, v189
    v_mfma_f32_16x16x32_bf16 v[48:51], v[140:143], v[12:15], v[200:203]
    ds_read_b128 v[120:123], v209 offset:12288
    buffer_store_dwordx4 v[52:55], v217, s[20:23], 0 offen offset:256 sc1
    v_mul_f32 v61, v61, v189
    v_mfma_f32_16x16x32_bf16 v[48:51], v[144:147], v[16:19], v[48:51]
    ds_read_b128 v[124:127], v208 offset:12416
    v_cvt_pk_bf16_f32 v60, v60, v61
    v_mfma_f32_16x16x32_bf16 v[48:51], v[148:151], v[20:23], v[48:51]
    ds_read_b128 v[128:131], v209 offset:12416
    v_exp_f32 v36, v36
    v_mul_f32 v62, v62, v189
    v_mfma_f32_16x16x32_bf16 v[48:51], v[152:155], v[24:27], v[48:51]
    ds_read_b128 v[132:135], v208 offset:12544
    v_exp_f32 v37, v37
    v_mul_f32 v63, v63, v189
    v_mfma_f32_16x16x32_bf16 v[48:51], v[156:159], v[28:31], v[48:51]
    ds_read_b128 v[136:139], v209 offset:12544
    v_exp_f32 v38, v38
    v_cvt_pk_bf16_f32 v61, v62, v63
    v_mfma_f32_16x16x32_bf16 v[48:51], v[160:163], v[32:35], v[48:51]
    v_add_u32 v212, 24576, v212
    v_exp_f32 v39, v39
    ds_read_b64_tr_b16 v[180:181], v212 offset:0
    v_mul_f32 v64, v64, v189
    v_mfma_f32_16x16x32_bf16 a[28:31], v[112:115], v[176:179], a[28:31]
    ds_read_b64_tr_b16 v[182:183], v212 offset:6144
    v_cvt_pk_bf16_f32 v68, v36, v37
    v_cvt_pk_bf16_f32 v69, v38, v39
    v_mul_f32 v65, v65, v189
    v_mfma_f32_16x16x32_bf16 a[28:31], v[108:111], v[172:175], a[28:31]
    s_waitcnt lgkmcnt(12)
    ds_read_b64_tr_b16 v[184:185], v212 offset:12288
    v_cvt_pk_bf16_f32 v62, v64, v65
    v_mfma_f32_16x16x32_bf16 v[36:39], v[116:119], a[240:243], v[196:199]
    s_waitcnt lgkmcnt(7)
    ds_read_b64_tr_b16 v[186:187], v212 offset:18432
    v_mul_f32 v66, v66, v189
    v_mfma_f32_16x16x32_bf16 v[36:39], v[120:123], a[244:247], v[36:39]
    s_waitcnt lgkmcnt(7)
    ds_read_b128 v[140:143], v208 offset:18432
    v_mul_f32 v67, v67, v189
    v_mfma_f32_16x16x32_bf16 v[36:39], v[124:127], a[248:251], v[36:39]
    s_waitcnt lgkmcnt(7)
    v_exp_f32 v40, v40
    v_cvt_pk_bf16_f32 v63, v66, v67
    v_mul_f32 v220, v220, v190
    v_mfma_f32_16x16x32_bf16 v[36:39], v[128:131], a[252:255], v[36:39]
    s_waitcnt lgkmcnt(6)
    v_exp_f32 v41, v41
    buffer_store_dwordx4 v[60:63], v217, s[20:23], 0 offen offset:3328 sc1
    v_mul_f32 v221, v221, v190
    v_mfma_f32_16x16x32_bf16 v[36:39], v[132:135], v[4:7], v[36:39]
    s_waitcnt lgkmcnt(5)
    v_exp_f32 v42, v42
    v_cvt_pk_bf16_f32 v220, v220, v221
    v_mfma_f32_16x16x32_bf16 v[36:39], v[136:139], v[8:11], v[36:39]
    s_waitcnt lgkmcnt(3)
    v_exp_f32 v43, v43
    v_mul_f32 v222, v222, v190
    v_mfma_f32_16x16x32_bf16 a[40:43], v[100:103], v[180:183], a[40:43]
    s_waitcnt lgkmcnt(1)
    v_cvt_pk_bf16_f32 v76, v40, v41
    v_cvt_pk_bf16_f32 v77, v42, v43
    v_mul_f32 v223, v223, v190
    v_mfma_f32_16x16x32_bf16 a[40:43], v[104:107], v[184:187], a[40:43]
    ds_read_b128 v[144:147], v209 offset:18432
    v_cvt_pk_bf16_f32 v221, v222, v223
    v_mfma_f32_16x16x32_bf16 v[40:43], v[116:119], v[12:15], v[200:203]
    ds_read_b128 v[148:151], v208 offset:18560
    v_mul_f32 v224, v224, v190
    v_mfma_f32_16x16x32_bf16 v[40:43], v[120:123], v[16:19], v[40:43]
    ds_read_b128 v[152:155], v209 offset:18560
    v_mul_f32 v225, v225, v190
    v_mfma_f32_16x16x32_bf16 v[40:43], v[124:127], v[20:23], v[40:43]
    v_exp_f32 v44, v44
    v_cvt_pk_bf16_f32 v222, v224, v225
    v_mfma_f32_16x16x32_bf16 v[40:43], v[128:131], v[24:27], v[40:43]
    ds_read_b128 v[156:159], v208 offset:18688
    v_exp_f32 v45, v45
    v_mul_f32 v226, v226, v190
    v_mfma_f32_16x16x32_bf16 v[40:43], v[132:135], v[28:31], v[40:43]
    ds_read_b128 v[160:163], v209 offset:18688
    v_exp_f32 v46, v46
    v_mul_f32 v227, v227, v190
    v_mfma_f32_16x16x32_bf16 v[40:43], v[136:139], v[32:35], v[40:43]
    v_add_u32 v213, 24576, v213
    v_exp_f32 v47, v47
    ds_read_b64_tr_b16 v[164:165], v213 offset:0
    v_cvt_pk_bf16_f32 v223, v226, v227
    v_mul_f32 v228, v228, v191
    v_mfma_f32_16x16x32_bf16 a[44:47], v[112:115], v[184:187], a[44:47]
    ds_read_b64_tr_b16 v[166:167], v213 offset:6144
    v_cvt_pk_bf16_f32 v70, v44, v45
    v_cvt_pk_bf16_f32 v71, v46, v47
    buffer_store_dwordx4 v[220:223], v217, s[20:23], s45 offen offset:256 sc1
    v_mul_f32 v229, v229, v191
    v_mfma_f32_16x16x32_bf16 a[44:47], v[108:111], v[180:183], a[44:47]
    s_waitcnt lgkmcnt(7)
    ds_read_b64_tr_b16 v[168:169], v213 offset:12288
    v_cvt_pk_bf16_f32 v228, v228, v229
    v_mfma_f32_16x16x32_bf16 v[44:47], v[140:143], a[240:243], v[196:199]
    s_waitcnt lgkmcnt(7)
    ds_read_b64_tr_b16 v[170:171], v213 offset:18432
    v_mul_f32 v230, v230, v191
    v_mfma_f32_16x16x32_bf16 v[44:47], v[144:147], a[244:247], v[44:47]
    s_waitcnt lgkmcnt(7)
    ds_read_b64_tr_b16 v[172:173], v210 offset:128
    v_mul_f32 v231, v231, v191
    v_mfma_f32_16x16x32_bf16 v[44:47], v[148:151], a[248:251], v[44:47]
    s_waitcnt lgkmcnt(7)
    v_exp_f32 v48, v48
    v_cvt_pk_bf16_f32 v229, v230, v231
    v_mfma_f32_16x16x32_bf16 v[44:47], v[152:155], a[252:255], v[44:47]
    s_waitcnt lgkmcnt(6)
    v_exp_f32 v49, v49
    v_mul_f32 v232, v232, v191
    v_mfma_f32_16x16x32_bf16 v[44:47], v[156:159], v[4:7], v[44:47]
    s_waitcnt lgkmcnt(5)
    v_exp_f32 v50, v50
    v_mul_f32 v233, v233, v191
    v_mfma_f32_16x16x32_bf16 v[44:47], v[160:163], v[8:11], v[44:47]
    s_waitcnt lgkmcnt(3)
    v_exp_f32 v51, v51
    v_cvt_pk_bf16_f32 v230, v232, v233
    v_mfma_f32_16x16x32_bf16 a[56:59], v[100:103], v[164:167], a[56:59]
    s_waitcnt lgkmcnt(1)
    v_cvt_pk_bf16_f32 v78, v48, v49
    v_cvt_pk_bf16_f32 v79, v50, v51
    v_mul_f32 v234, v234, v191
    v_mfma_f32_16x16x32_bf16 a[56:59], v[104:107], v[168:171], a[56:59]
    ds_read_b64_tr_b16 v[174:175], v210 offset:6272
    v_mul_f32 v235, v235, v191
    v_mfma_f32_16x16x32_bf16 v[48:51], v[140:143], v[12:15], v[200:203]
    ds_read_b64_tr_b16 v[176:177], v210 offset:12416
    v_cvt_pk_bf16_f32 v231, v234, v235
    v_mfma_f32_16x16x32_bf16 v[48:51], v[144:147], v[16:19], v[48:51]
    ds_read_b64_tr_b16 v[178:179], v210 offset:18560
    buffer_store_dwordx4 v[228:231], v217, s[20:23], s45 offen offset:3328 sc1
    v_mfma_f32_16x16x32_bf16 v[48:51], v[148:151], v[20:23], v[48:51]
    ds_read_b64_tr_b16 v[180:181], v211 offset:128
    v_add_u32 v0, -49152, v210
    v_mfma_f32_16x16x32_bf16 v[48:51], v[152:155], v[24:27], v[48:51]
    ds_read_b64_tr_b16 v[182:183], v211 offset:6272
    v_add_u32 v1, -49152, v211
    v_mfma_f32_16x16x32_bf16 v[48:51], v[156:159], v[28:31], v[48:51]
    ds_read_b64_tr_b16 v[184:185], v211 offset:12416
    v_add_u32 v2, -49152, v212
    v_mfma_f32_16x16x32_bf16 v[48:51], v[160:163], v[32:35], v[48:51]
    ds_read_b64_tr_b16 v[186:187], v211 offset:18560
    v_add_u32 v3, -49152, v213
    v_mfma_f32_16x16x32_bf16 a[60:63], v[112:115], v[168:171], a[60:63]
    v_exp_f32 v36, v36
    v_mfma_f32_16x16x32_bf16 a[60:63], v[108:111], v[164:167], a[60:63]
    v_exp_f32 v37, v37
    v_smfmac_f32_16x16x64_bf16 v[252:255], v[244:247], v[100:107], v218
    v_exp_f32 v38, v38
    v_smfmac_f32_16x16x64_bf16 v[252:255], v[248:251], v[108:115], v218
    s_waitcnt lgkmcnt(6)
    ds_read_b64_tr_b16 v[164:165], v212 offset:128
    v_exp_f32 v39, v39
    v_mfma_f32_16x16x32_bf16 a[72:75], v[100:103], v[172:175], a[72:75]
    s_waitcnt lgkmcnt(5)
    ds_read_b64_tr_b16 v[166:167], v212 offset:6272
    v_exp_f32 v40, v40
    v_mfma_f32_16x16x32_bf16 a[72:75], v[104:107], v[176:179], a[72:75]
    ds_read_b64_tr_b16 v[168:169], v212 offset:12416
    v_exp_f32 v41, v41
    v_mfma_f32_16x16x32_bf16 a[76:79], v[112:115], v[176:179], a[76:79]
    ds_read_b64_tr_b16 v[170:171], v212 offset:18560
    v_exp_f32 v42, v42
    v_mfma_f32_16x16x32_bf16 a[76:79], v[108:111], v[172:175], a[76:79]
    s_waitcnt lgkmcnt(6)
    ds_read_b64_tr_b16 v[172:173], v0 offset:0
    v_exp_f32 v43, v43
    v_mfma_f32_16x16x32_bf16 a[88:91], v[100:103], v[180:183], a[88:91]
    s_waitcnt lgkmcnt(5)
    ds_read_b64_tr_b16 v[174:175], v0 offset:6144
    v_exp_f32 v44, v44
    v_mfma_f32_16x16x32_bf16 a[88:91], v[104:107], v[184:187], a[88:91]
    ds_read_b64_tr_b16 v[176:177], v0 offset:12288
    v_exp_f32 v45, v45
    v_mfma_f32_16x16x32_bf16 a[92:95], v[112:115], v[184:187], a[92:95]
    ds_read_b64_tr_b16 v[178:179], v0 offset:18432
    v_exp_f32 v46, v46
    v_mfma_f32_16x16x32_bf16 a[92:95], v[108:111], v[180:183], a[92:95]
    s_waitcnt lgkmcnt(6)
    v_exp_f32 v47, v47
    v_mfma_f32_16x16x32_bf16 a[104:107], v[100:103], v[164:167], a[104:107]
    s_waitcnt lgkmcnt(4)
    v_exp_f32 v48, v48
    v_mfma_f32_16x16x32_bf16 a[104:107], v[104:107], v[168:171], a[104:107]
    ds_read_b64_tr_b16 v[180:181], v1 offset:0
    v_exp_f32 v49, v49
    v_mfma_f32_16x16x32_bf16 a[108:111], v[112:115], v[168:171], a[108:111]
    ds_read_b64_tr_b16 v[182:183], v1 offset:6144
    v_exp_f32 v50, v50
    v_mfma_f32_16x16x32_bf16 a[108:111], v[108:111], v[164:167], a[108:111]
    s_waitcnt lgkmcnt(4)
    ds_read_b64_tr_b16 v[184:185], v1 offset:12288
    v_cvt_pk_bf16_f32 v72, v36, v37
    v_cvt_pk_bf16_f32 v73, v38, v39
    v_cvt_pk_bf16_f32 v74, v44, v45
    v_cvt_pk_bf16_f32 v75, v46, v47
    v_exp_f32 v51, v51
    v_mfma_f32_16x16x32_bf16 a[8:11], v[68:71], v[172:175], a[8:11]
    s_waitcnt lgkmcnt(3)
    ds_read_b64_tr_b16 v[186:187], v1 offset:18432
    v_cvt_pk_bf16_f32 v80, v40, v41
    v_cvt_pk_bf16_f32 v81, v42, v43
    v_cvt_pk_bf16_f32 v82, v48, v49
    v_cvt_pk_bf16_f32 v83, v50, v51
    v_mfma_f32_16x16x32_bf16 a[8:11], v[72:75], v[176:179], a[8:11]
    ds_read_b64_tr_b16 v[164:165], v2 offset:0
    v_mfma_f32_16x16x32_bf16 a[12:15], v[80:83], v[176:179], a[12:15]
    ds_read_b64_tr_b16 v[166:167], v2 offset:6144
    v_mfma_f32_16x16x32_bf16 a[12:15], v[76:79], v[172:175], a[12:15]
    ds_read_b64_tr_b16 v[168:169], v2 offset:12288
    v_smfmac_f32_16x16x64_bf16 v[252:255], v[244:247], v[68:75], v218
    ds_read_b64_tr_b16 v[170:171], v2 offset:18432
    s_nop 0
    ds_write2_b32 v238, a8, a9 offset0:0 offset1:132
    v_smfmac_f32_16x16x64_bf16 v[252:255], v[248:251], v[76:83], v218
    s_waitcnt lgkmcnt(7)
    ds_read_b64_tr_b16 v[172:173], v3 offset:0
    ds_write2_b32 v238, a10, a11 offset0:64 offset1:196
    v_mfma_f32_16x16x32_bf16 a[24:27], v[68:71], v[180:183], a[24:27]
    s_waitcnt lgkmcnt(7)
    ds_read_b64_tr_b16 v[174:175], v3 offset:6144
    ds_write2_b32 v240, a12, a13 offset0:0 offset1:132
    v_mfma_f32_16x16x32_bf16 a[24:27], v[72:75], v[184:187], a[24:27]
    ds_read_b64_tr_b16 v[176:177], v3 offset:12288
    ds_write2_b32 v240, a14, a15 offset0:64 offset1:196
    v_mfma_f32_16x16x32_bf16 a[28:31], v[80:83], v[184:187], a[28:31]
    ds_read_b64_tr_b16 v[178:179], v3 offset:18432
    v_add_f32 v252, v252, v253
    v_rcp_f32 v236, v252
    v_add_f32 v254, v254, v255
    v_rcp_f32 v237, v254
    v_mfma_f32_16x16x32_bf16 a[28:31], v[76:79], v[180:183], a[28:31]
    s_waitcnt lgkmcnt(10)
    ds_read_b64_tr_b16 v[180:181], v0 offset:128
    v_mfma_f32_16x16x32_bf16 a[40:43], v[68:71], v[164:167], a[40:43]
    s_waitcnt lgkmcnt(9)
    ds_read_b64_tr_b16 v[182:183], v0 offset:6272
    ds_write2_b32 v238, a24, a25 offset0:16 offset1:148
    v_mfma_f32_16x16x32_bf16 a[40:43], v[72:75], v[168:171], a[40:43]
    ds_read_b64_tr_b16 v[184:185], v0 offset:12416
    ds_write2_b32 v238, a26, a27 offset0:80 offset1:212
    v_mfma_f32_16x16x32_bf16 a[44:47], v[80:83], v[168:171], a[44:47]
    ds_read_b64_tr_b16 v[186:187], v0 offset:18560
    ds_write2_b32 v240, a28, a29 offset0:16 offset1:148
    v_mfma_f32_16x16x32_bf16 a[44:47], v[76:79], v[164:167], a[44:47]
    s_waitcnt lgkmcnt(11)
    ds_read_b64_tr_b16 v[164:165], v1 offset:128
    ds_write2_b32 v240, a30, a31 offset0:80 offset1:212
    v_mfma_f32_16x16x32_bf16 a[56:59], v[68:71], v[172:175], a[56:59]
    s_waitcnt lgkmcnt(9)
    ds_read_b64_tr_b16 v[166:167], v1 offset:6272
    ds_write_b32 v242, v236 offset:512
    v_mfma_f32_16x16x32_bf16 a[56:59], v[72:75], v[176:179], a[56:59]
    ds_read_b64_tr_b16 v[168:169], v1 offset:12416
    ds_read2_b32 v[192:193], v243 offset0:128 offset1:136
    ds_write_b32 v242, v237 offset:768
    v_mfma_f32_16x16x32_bf16 a[60:63], v[80:83], v[176:179], a[60:63]
    ds_read_b64_tr_b16 v[170:171], v1 offset:18560
    ds_read2_b32 v[194:195], v243 offset0:192 offset1:200
    ds_write2_b32 v238, a40, a41 offset0:32 offset1:164
    v_mfma_f32_16x16x32_bf16 a[60:63], v[76:79], v[172:175], a[60:63]
    s_waitcnt lgkmcnt(15)
    ds_read_b64_tr_b16 v[172:173], v2 offset:128
    ds_write2_b32 v238, a42, a43 offset0:96 offset1:228
    v_mfma_f32_16x16x32_bf16 a[72:75], v[68:71], v[180:183], a[72:75]
    s_waitcnt lgkmcnt(13)
    ds_read_b64_tr_b16 v[174:175], v2 offset:6272
    ds_write2_b32 v240, a44, a45 offset0:32 offset1:164
    v_mfma_f32_16x16x32_bf16 a[72:75], v[72:75], v[184:187], a[72:75]
    ds_read_b64_tr_b16 v[176:177], v2 offset:12416
    ds_write2_b32 v240, a46, a47 offset0:96 offset1:228
    v_mfma_f32_16x16x32_bf16 a[76:79], v[80:83], v[184:187], a[76:79]
    ds_read_b64_tr_b16 v[178:179], v2 offset:18560
    ds_write2_b32 v238, a56, a57 offset0:48 offset1:180
    v_mfma_f32_16x16x32_bf16 a[76:79], v[76:79], v[180:183], a[76:79]
    s_waitcnt lgkmcnt(15)
    ds_read_b64_tr_b16 v[180:181], v213 offset:128
    ds_write2_b32 v238, a58, a59 offset0:112 offset1:244
    v_mfma_f32_16x16x32_bf16 a[88:91], v[68:71], v[164:167], a[88:91]
    s_waitcnt lgkmcnt(12)
    ds_read_b64_tr_b16 v[182:183], v213 offset:6272
    ds_read_b128 v[116:119], v239 offset:0
    ds_read_b128 v[120:123], v239 offset:16
    v_mfma_f32_16x16x32_bf16 a[88:91], v[72:75], v[168:171], a[88:91]
    ds_read_b64_tr_b16 v[184:185], v213 offset:12416
    ds_read_b128 v[124:127], v239 offset:2176
    ds_read_b128 v[128:131], v239 offset:2192
    v_mfma_f32_16x16x32_bf16 a[92:95], v[80:83], v[168:171], a[92:95]
    ds_read_b64_tr_b16 v[186:187], v213 offset:18560
    ds_write2_b32 v240, a60, a61 offset0:48 offset1:180
    v_mfma_f32_16x16x32_bf16 a[92:95], v[76:79], v[164:167], a[92:95]
    s_waitcnt lgkmcnt(15)
    ds_read_b64_tr_b16 v[164:165], v3 offset:128
    ds_write2_b32 v240, a62, a63 offset0:112 offset1:244
    v_mfma_f32_16x16x32_bf16 a[104:107], v[68:71], v[172:175], a[104:107]
    s_waitcnt lgkmcnt(13)
    ds_read_b64_tr_b16 v[166:167], v3 offset:6272
    ds_read_b128 v[132:135], v241 offset:0
    ds_read_b128 v[136:139], v241 offset:16
    v_mfma_f32_16x16x32_bf16 a[104:107], v[72:75], v[176:179], a[104:107]
    ds_read_b64_tr_b16 v[168:169], v3 offset:12416
    ds_read_b128 v[140:143], v241 offset:2176
    ds_read_b128 v[144:147], v241 offset:2192
    v_mfma_f32_16x16x32_bf16 a[108:111], v[80:83], v[176:179], a[108:111]
    s_waitcnt lgkmcnt(13)
    ds_read_b64_tr_b16 v[170:171], v3 offset:18560
    ds_write2_b32 v238, a72, a73 offset0:0 offset1:132
    v_mul_f32 v116, v116, v192
    v_mul_f32 v117, v117, v192
    v_cvt_pk_bf16_f32 v116, v116, v117
    v_mul_f32 v118, v118, v192
    v_mul_f32 v119, v119, v192
    v_cvt_pk_bf16_f32 v117, v118, v119
    v_mul_f32 v120, v120, v192
    v_mul_f32 v121, v121, v192
    v_cvt_pk_bf16_f32 v118, v120, v121
    v_mul_f32 v122, v122, v192
    v_mul_f32 v123, v123, v192
    v_cvt_pk_bf16_f32 v119, v122, v123
    buffer_store_dwordx4 v[116:119], v217, s[20:23], s46 offen offset:0 sc1
    v_mfma_f32_16x16x32_bf16 a[108:111], v[76:79], v[172:175], a[108:111]
    s_waitcnt lgkmcnt(13)
    ds_read_b64_tr_b16 v[172:173], v210 offset:256
    ds_write2_b32 v238, a74, a75 offset0:64 offset1:196
    v_mul_f32 v124, v124, v193
    v_mul_f32 v125, v125, v193
    v_cvt_pk_bf16_f32 v124, v124, v125
    v_mfma_f32_16x16x32_bf16 a[120:123], v[100:103], v[180:183], a[120:123]
    s_waitcnt lgkmcnt(13)
    ds_read_b64_tr_b16 v[174:175], v210 offset:6400
    ds_write2_b32 v240, a76, a77 offset0:0 offset1:132
    v_mul_f32 v126, v126, v193
    v_mul_f32 v127, v127, v193
    v_mfma_f32_16x16x32_bf16 a[120:123], v[104:107], v[184:187], a[120:123]
    ds_read_b64_tr_b16 v[176:177], v210 offset:12544
    ds_write2_b32 v240, a78, a79 offset0:64 offset1:196
    v_cvt_pk_bf16_f32 v125, v126, v127
    v_mul_f32 v128, v128, v193
    v_mfma_f32_16x16x32_bf16 a[124:127], v[112:115], v[184:187], a[124:127]
    ds_read_b64_tr_b16 v[178:179], v210 offset:18688
    ds_write2_b32 v238, a88, a89 offset0:16 offset1:148
    v_mul_f32 v129, v129, v193
    v_cvt_pk_bf16_f32 v126, v128, v129
    v_mfma_f32_16x16x32_bf16 a[124:127], v[108:111], v[180:183], a[124:127]
    s_waitcnt lgkmcnt(15)
    ds_read_b64_tr_b16 v[180:181], v0 offset:256
    ds_write2_b32 v238, a90, a91 offset0:80 offset1:212
    v_mul_f32 v130, v130, v193
    v_mul_f32 v131, v131, v193
    v_mfma_f32_16x16x32_bf16 a[120:123], v[68:71], v[164:167], a[120:123]
    s_waitcnt lgkmcnt(11)
    ds_read_b64_tr_b16 v[182:183], v0 offset:6400
    ds_write2_b32 v240, a92, a93 offset0:16 offset1:148
    v_cvt_pk_bf16_f32 v127, v130, v131
    buffer_store_dwordx4 v[124:127], v217, s[20:23], s46 offen offset:3072 sc1
    v_mul_f32 v132, v132, v194
    v_mfma_f32_16x16x32_bf16 a[120:123], v[72:75], v[168:171], a[120:123]
    ds_read_b64_tr_b16 v[184:185], v0 offset:12544
    ds_write2_b32 v240, a94, a95 offset0:80 offset1:212
    v_mul_f32 v133, v133, v194
    v_cvt_pk_bf16_f32 v132, v132, v133
    v_mfma_f32_16x16x32_bf16 a[124:127], v[80:83], v[168:171], a[124:127]
    ds_read_b64_tr_b16 v[186:187], v0 offset:18688
    ds_write2_b32 v238, a104, a105 offset0:32 offset1:164
    v_mul_f32 v134, v134, v194
    v_mul_f32 v135, v135, v194
    v_mfma_f32_16x16x32_bf16 a[124:127], v[76:79], v[164:167], a[124:127]
    s_waitcnt lgkmcnt(13)
    ds_read_b64_tr_b16 v[164:165], v211 offset:256
    ds_write2_b32 v238, a106, a107 offset0:96 offset1:228
    v_cvt_pk_bf16_f32 v133, v134, v135
    v_mul_f32 v136, v136, v194
    v_mfma_f32_16x16x32_bf16 a[136:139], v[100:103], v[172:175], a[136:139]
    s_waitcnt lgkmcnt(11)
    ds_read_b64_tr_b16 v[166:167], v211 offset:6400
    ds_write2_b32 v240, a108, a109 offset0:32 offset1:164
    v_mul_f32 v137, v137, v194
    v_cvt_pk_bf16_f32 v134, v136, v137
    v_mfma_f32_16x16x32_bf16 a[136:139], v[104:107], v[176:179], a[136:139]
    ds_read_b64_tr_b16 v[168:169], v211 offset:12544
    ds_write2_b32 v240, a110, a111 offset0:96 offset1:228
    v_mul_f32 v138, v138, v194
    v_mul_f32 v139, v139, v194
    v_mfma_f32_16x16x32_bf16 a[140:143], v[112:115], v[176:179], a[140:143]
    ds_read_b64_tr_b16 v[170:171], v211 offset:18688
    ds_write2_b32 v238, a120, a121 offset0:48 offset1:180
    v_cvt_pk_bf16_f32 v135, v138, v139
    buffer_store_dwordx4 v[132:135], v217, s[20:23], s47 offen offset:0 sc1
    v_mul_f32 v140, v140, v195
    v_mfma_f32_16x16x32_bf16 a[140:143], v[108:111], v[172:175], a[140:143]
    s_waitcnt lgkmcnt(13)
    ds_read_b64_tr_b16 v[172:173], v1 offset:256
    ds_write2_b32 v238, a122, a123 offset0:112 offset1:244
    v_mul_f32 v141, v141, v195
    v_cvt_pk_bf16_f32 v140, v140, v141
    v_mfma_f32_16x16x32_bf16 a[136:139], v[68:71], v[180:183], a[136:139]
    s_waitcnt lgkmcnt(11)
    ds_read_b64_tr_b16 v[174:175], v1 offset:6400
    ds_read_b128 v[148:151], v239 offset:0
    ds_read_b128 v[152:155], v239 offset:16
    v_mul_f32 v142, v142, v195
    v_mul_f32 v143, v143, v195
    v_mfma_f32_16x16x32_bf16 a[136:139], v[72:75], v[184:187], a[136:139]
    ds_read_b64_tr_b16 v[176:177], v1 offset:12544
    ds_read_b128 v[156:159], v239 offset:2176
    ds_read_b128 v[160:163], v239 offset:2192
    v_cvt_pk_bf16_f32 v141, v142, v143
    v_mul_f32 v144, v144, v195
    v_mfma_f32_16x16x32_bf16 a[140:143], v[80:83], v[184:187], a[140:143]
    ds_read_b64_tr_b16 v[178:179], v1 offset:18688
    ds_write2_b32 v240, a124, a125 offset0:48 offset1:180
    v_mul_f32 v145, v145, v195
    v_cvt_pk_bf16_f32 v142, v144, v145
    v_mfma_f32_16x16x32_bf16 a[140:143], v[76:79], v[180:183], a[140:143]
    s_waitcnt lgkmcnt(15)
    ds_read_b64_tr_b16 v[180:181], v212 offset:256
    ds_write2_b32 v240, a126, a127 offset0:112 offset1:244
    v_mul_f32 v146, v146, v195
    v_mul_f32 v147, v147, v195
    v_mfma_f32_16x16x32_bf16 a[152:155], v[100:103], v[164:167], a[152:155]
    s_waitcnt lgkmcnt(13)
    ds_read_b64_tr_b16 v[182:183], v212 offset:6400
    ds_read_b128 v[84:87], v241 offset:0
    ds_read_b128 v[88:91], v241 offset:16
    v_cvt_pk_bf16_f32 v143, v146, v147
    buffer_store_dwordx4 v[140:143], v217, s[20:23], s47 offen offset:3072 sc1
    v_mfma_f32_16x16x32_bf16 a[152:155], v[104:107], v[168:171], a[152:155]
    ds_read_b64_tr_b16 v[184:185], v212 offset:12544
    ds_read_b128 v[92:95], v241 offset:2176
    ds_read_b128 v[96:99], v241 offset:2192
    v_mfma_f32_16x16x32_bf16 a[156:159], v[112:115], v[168:171], a[156:159]
    s_waitcnt lgkmcnt(14)
    ds_read_b64_tr_b16 v[186:187], v212 offset:18688
    ds_write2_b32 v238, a136, a137 offset0:0 offset1:132
    v_mul_f32 v148, v148, v192
    v_mfma_f32_16x16x32_bf16 a[156:159], v[108:111], v[164:167], a[156:159]
    ds_read_b64_tr_b16 v[164:165], v2 offset:256
    ds_write2_b32 v238, a138, a139 offset0:64 offset1:196
    v_mul_f32 v149, v149, v192
    v_cvt_pk_bf16_f32 v148, v148, v149
    v_mfma_f32_16x16x32_bf16 a[152:155], v[68:71], v[172:175], a[152:155]
    s_waitcnt lgkmcnt(13)
    ds_read_b64_tr_b16 v[166:167], v2 offset:6400
    ds_write2_b32 v240, a140, a141 offset0:0 offset1:132
    v_mul_f32 v150, v150, v192
    v_mul_f32 v151, v151, v192
    v_mfma_f32_16x16x32_bf16 a[152:155], v[72:75], v[176:179], a[152:155]
    ds_read_b64_tr_b16 v[168:169], v2 offset:12544
    ds_write2_b32 v240, a142, a143 offset0:64 offset1:196
    v_cvt_pk_bf16_f32 v149, v150, v151
    v_mul_f32 v152, v152, v192
    v_mfma_f32_16x16x32_bf16 a[156:159], v[80:83], v[176:179], a[156:159]
    ds_read_b64_tr_b16 v[170:171], v2 offset:18688
    v_mul_f32 v153, v153, v192
    v_cvt_pk_bf16_f32 v150, v152, v153
    v_mfma_f32_16x16x32_bf16 a[156:159], v[76:79], v[172:175], a[156:159]
    s_waitcnt lgkmcnt(14)
    ds_read_b64_tr_b16 v[172:173], v213 offset:256
    v_mul_f32 v154, v154, v192
    v_mul_f32 v155, v155, v192
    v_mfma_f32_16x16x32_bf16 a[168:171], v[100:103], v[180:183], a[168:171]
    s_waitcnt lgkmcnt(9)
    ds_read_b64_tr_b16 v[174:175], v213 offset:6400
    ds_write2_b32 v238, a152, a153 offset0:16 offset1:148
    v_cvt_pk_bf16_f32 v151, v154, v155
    buffer_store_dwordx4 v[148:151], v217, s[20:23], s46 offen offset:128 sc1
    v_mul_f32 v156, v156, v193
    v_mfma_f32_16x16x32_bf16 a[168:171], v[104:107], v[184:187], a[168:171]
    ds_read_b64_tr_b16 v[176:177], v213 offset:12544
    ds_write2_b32 v238, a154, a155 offset0:80 offset1:212
    v_mul_f32 v157, v157, v193
    v_cvt_pk_bf16_f32 v156, v156, v157
    v_mfma_f32_16x16x32_bf16 a[172:175], v[112:115], v[184:187], a[172:175]
    ds_read_b64_tr_b16 v[178:179], v213 offset:18688
    ds_write2_b32 v240, a156, a157 offset0:16 offset1:148
    v_mul_f32 v158, v158, v193
    v_mul_f32 v159, v159, v193
    v_mfma_f32_16x16x32_bf16 a[172:175], v[108:111], v[180:183], a[172:175]
    s_waitcnt lgkmcnt(11)
    ds_read_b64_tr_b16 v[180:181], v3 offset:256
    ds_write2_b32 v240, a158, a159 offset0:80 offset1:212
    v_cvt_pk_bf16_f32 v157, v158, v159
    v_mul_f32 v160, v160, v193
    v_mfma_f32_16x16x32_bf16 a[168:171], v[68:71], v[164:167], a[168:171]
    s_waitcnt lgkmcnt(9)
    ds_read_b64_tr_b16 v[182:183], v3 offset:6400
    v_mul_f32 v161, v161, v193
    v_cvt_pk_bf16_f32 v158, v160, v161
    v_mfma_f32_16x16x32_bf16 a[168:171], v[72:75], v[168:171], a[168:171]
    ds_read_b64_tr_b16 v[184:185], v3 offset:12544
    v_mul_f32 v162, v162, v193
    v_mul_f32 v163, v163, v193
    v_mfma_f32_16x16x32_bf16 a[172:175], v[80:83], v[168:171], a[172:175]
    ds_read_b64_tr_b16 v[186:187], v3 offset:18688
    v_cvt_pk_bf16_f32 v159, v162, v163
    buffer_store_dwordx4 v[156:159], v217, s[20:23], s46 offen offset:3200 sc1
    v_mul_f32 v84, v84, v194
    v_mfma_f32_16x16x32_bf16 a[172:175], v[76:79], v[164:167], a[172:175]
    s_waitcnt lgkmcnt(10)
    v_mul_f32 v85, v85, v194
    v_cvt_pk_bf16_f32 v84, v84, v85
    v_mfma_f32_16x16x32_bf16 a[184:187], v[100:103], v[172:175], a[184:187]
    s_waitcnt lgkmcnt(6)
    ds_write2_b32 v238, a168, a169 offset0:32 offset1:164
    v_mul_f32 v86, v86, v194
    v_mul_f32 v87, v87, v194
    v_mfma_f32_16x16x32_bf16 a[184:187], v[104:107], v[176:179], a[184:187]
    ds_write2_b32 v238, a170, a171 offset0:96 offset1:228
    v_cvt_pk_bf16_f32 v85, v86, v87
    v_mul_f32 v88, v88, v194
    v_mfma_f32_16x16x32_bf16 a[188:191], v[112:115], v[176:179], a[188:191]
    ds_write2_b32 v240, a172, a173 offset0:32 offset1:164
    v_mul_f32 v89, v89, v194
    v_cvt_pk_bf16_f32 v86, v88, v89
    v_mfma_f32_16x16x32_bf16 a[188:191], v[108:111], v[172:175], a[188:191]
    s_waitcnt lgkmcnt(5)
    ds_write2_b32 v240, a174, a175 offset0:96 offset1:228
    v_mul_f32 v90, v90, v194
    v_mul_f32 v91, v91, v194
    v_mfma_f32_16x16x32_bf16 a[184:187], v[68:71], v[180:183], a[184:187]
    s_waitcnt lgkmcnt(4)
    v_cvt_pk_bf16_f32 v87, v90, v91
    buffer_store_dwordx4 v[84:87], v217, s[20:23], s47 offen offset:128 sc1
    v_mfma_f32_16x16x32_bf16 a[184:187], v[72:75], v[184:187], a[184:187]
    v_mul_f32 v92, v92, v195
    v_mul_f32 v93, v93, v195
    v_mfma_f32_16x16x32_bf16 a[188:191], v[80:83], v[184:187], a[188:191]
    s_nop 0
    s_nop 3
    ds_write2_b32 v238, a184, a185 offset0:48 offset1:180
    v_mfma_f32_16x16x32_bf16 a[188:191], v[76:79], v[180:183], a[188:191]
    v_cvt_pk_bf16_f32 v92, v92, v93
    v_mul_f32 v94, v94, v195
    v_mul_f32 v95, v95, v195
    v_cvt_pk_bf16_f32 v93, v94, v95
    v_mul_f32 v96, v96, v195
    v_mul_f32 v97, v97, v195
    v_cvt_pk_bf16_f32 v94, v96, v97
    v_mul_f32 v98, v98, v195
    v_mul_f32 v99, v99, v195
    v_cvt_pk_bf16_f32 v95, v98, v99
    buffer_store_dwordx4 v[92:95], v217, s[20:23], s47 offen offset:3200 sc1
    ds_write2_b32 v238, a186, a187 offset0:112 offset1:244
    ds_read_b128 v[52:55], v239 offset:0
    ds_read_b128 v[56:59], v239 offset:16
    ds_read_b128 v[60:63], v239 offset:2176
    ds_read_b128 v[64:67], v239 offset:2192
    ds_write2_b32 v240, a188, a189 offset0:48 offset1:180
    ds_write2_b32 v240, a190, a191 offset0:112 offset1:244
    ds_read_b128 v[220:223], v241 offset:0
    ds_read_b128 v[224:227], v241 offset:16
    ds_read_b128 v[228:231], v241 offset:2176
    ds_read_b128 v[232:235], v241 offset:2192
    s_waitcnt lgkmcnt(9)
    v_pk_mul_f32 v[52:53], v[52:53], v[192:193] op_sel:[0,0] op_sel_hi:[1,0]
    v_cvt_pk_bf16_f32 v52, v52, v53
    v_pk_mul_f32 v[54:55], v[54:55], v[192:193] op_sel:[0,0] op_sel_hi:[1,0]
    v_cvt_pk_bf16_f32 v53, v54, v55
    s_waitcnt lgkmcnt(8)
    v_pk_mul_f32 v[56:57], v[56:57], v[192:193] op_sel:[0,0] op_sel_hi:[1,0]
    v_cvt_pk_bf16_f32 v54, v56, v57
    v_pk_mul_f32 v[58:59], v[58:59], v[192:193] op_sel:[0,0] op_sel_hi:[1,0]
    v_cvt_pk_bf16_f32 v55, v58, v59
    buffer_store_dwordx4 v[52:55], v217, s[20:23], s46 offen offset:256 sc1
    s_waitcnt lgkmcnt(7)
    v_pk_mul_f32 v[60:61], v[60:61], v[192:193] op_sel:[0,1] op_sel_hi:[1,1]
    v_cvt_pk_bf16_f32 v60, v60, v61
    v_pk_mul_f32 v[62:63], v[62:63], v[192:193] op_sel:[0,1] op_sel_hi:[1,1]
    v_cvt_pk_bf16_f32 v61, v62, v63
    s_waitcnt lgkmcnt(6)
    v_pk_mul_f32 v[64:65], v[64:65], v[192:193] op_sel:[0,1] op_sel_hi:[1,1]
    v_cvt_pk_bf16_f32 v62, v64, v65
    v_pk_mul_f32 v[66:67], v[66:67], v[192:193] op_sel:[0,1] op_sel_hi:[1,1]
    v_cvt_pk_bf16_f32 v63, v66, v67
    buffer_store_dwordx4 v[60:63], v217, s[20:23], s46 offen offset:3328 sc1
    s_waitcnt lgkmcnt(3)
    v_pk_mul_f32 v[220:221], v[220:221], v[194:195] op_sel:[0,0] op_sel_hi:[1,0]
    v_cvt_pk_bf16_f32 v220, v220, v221
    v_pk_mul_f32 v[222:223], v[222:223], v[194:195] op_sel:[0,0] op_sel_hi:[1,0]
    v_cvt_pk_bf16_f32 v221, v222, v223
    s_waitcnt lgkmcnt(2)
    v_pk_mul_f32 v[224:225], v[224:225], v[194:195] op_sel:[0,0] op_sel_hi:[1,0]
    v_cvt_pk_bf16_f32 v222, v224, v225
    v_pk_mul_f32 v[226:227], v[226:227], v[194:195] op_sel:[0,0] op_sel_hi:[1,0]
    v_cvt_pk_bf16_f32 v223, v226, v227
    buffer_store_dwordx4 v[220:223], v217, s[20:23], s47 offen offset:256 sc1
    s_waitcnt lgkmcnt(1)
    v_pk_mul_f32 v[228:229], v[228:229], v[194:195] op_sel:[0,1] op_sel_hi:[1,1]
    v_cvt_pk_bf16_f32 v228, v228, v229
    v_pk_mul_f32 v[230:231], v[230:231], v[194:195] op_sel:[0,1] op_sel_hi:[1,1]
    v_cvt_pk_bf16_f32 v229, v230, v231
    s_waitcnt lgkmcnt(0)
    v_pk_mul_f32 v[232:233], v[232:233], v[194:195] op_sel:[0,1] op_sel_hi:[1,1]
    v_cvt_pk_bf16_f32 v230, v232, v233
    v_pk_mul_f32 v[234:235], v[234:235], v[194:195] op_sel:[0,1] op_sel_hi:[1,1]
    v_cvt_pk_bf16_f32 v231, v234, v235
    buffer_store_dwordx4 v[228:231], v217, s[20:23], s47 offen offset:3328 sc1

    s_mov_b32 s36, 0x5d800000
    v_add_f32 v220, v204, v206
    v_add_f32 v221, v252, v254
    v_add_f32 v220, v220, v221
    v_cmp_ngt_f32 vcc, s36, v220
    s_nop 4
    s_cmp_lg_u64 vcc, 0
    s_cselect_b32 s36, 1, 0
    s_lshl_b32 s37, s33, 2
    s_add_u32 s37, s37, 147456
    v_mov_b32 v221, s36
    v_mov_b32 v222, s37
    ds_write_b32 v222, v221
    v_mov_b32 v222, 147456
    s_waitcnt lgkmcnt(0)
    s_barrier
    ds_read_b128 v[228:231], v222
    s_waitcnt lgkmcnt(0)
    v_or_b32 v220, v228, v229
    v_or3_b32 v220, v220, v230, v231
    s_nop 0
    v_readfirstlane_b32 s36, v220
    s_nop 3
    s_andn2_b32 s36, s36, s35
    s_cbranch_scc0 L_end
    s_mov_b32 s35, 1
    s_waitcnt vmcnt(0)
    s_barrier
    s_mul_i32 s28, s33, 6144
    s_mov_b32 s24, 0
    s_mov_b32 s26, 3072
    v_mbcnt_lo_u32_b32 v220, -1, 0
    v_mbcnt_hi_u32_b32 v220, -1, v220
    v_and_b32 v224, 15, v220
    v_lshrrev_b32 v221, 4, v220
    v_and_b32 v222, 6, v224
    v_xor_b32 v221, v221, v222
    v_mul_u32_u24 v223, 0x180, v224
    v_lshl_add_u32 v208, v221, 4, v223
    v_xor_b32 v221, 4, v221
    v_lshl_add_u32 v209, v221, 4, v223
    v_lshrrev_b32 v224, 2, v220
    v_mul_u32_u24 v223, 0x180, v224
    v_and_b32 v221, 1, v220
    v_lshl_add_u32 v223, v221, 3, v223
    v_add_u32 v223, 73728, v223
    v_bfe_u32 v221, v220, 1, 1
    v_and_b32 v222, 6, v224
    v_xor_b32 v221, v221, v222
    v_xor_b32 v222, 0, v221
    v_lshl_add_u32 v210, v222, 4, v223
    v_xor_b32 v222, 2, v221
    v_lshl_add_u32 v211, v222, 4, v223
    v_xor_b32 v222, 4, v221
    v_lshl_add_u32 v212, v222, 4, v223
    v_xor_b32 v222, 6, v221
    v_lshl_add_u32 v213, v222, 4, v223
    v_mov_b32 v204, 0xff800000
    v_mov_b32 v205, 0xff800000
    v_mov_b32 v206, 0xff800000
    v_mov_b32 v207, 0xff800000
L_fb:
    s_mov_b32 m0, s28
    s_nop 0
    buffer_load_dwordx4 v214, s[12:15], s24 offen offset:0 lds
    buffer_load_dwordx4 v215, s[12:15], s24 offen offset:1024 lds
    buffer_load_dwordx4 v216, s[12:15], s24 offen offset:2048 lds
    s_add_u32 m0, s28, 3072
    s_nop 0
    buffer_load_dwordx4 v214, s[12:15], s26 offen offset:0 lds
    buffer_load_dwordx4 v215, s[12:15], s26 offen offset:1024 lds
    buffer_load_dwordx4 v216, s[12:15], s26 offen offset:2048 lds
    s_waitcnt vmcnt(0)
    s_barrier
    ds_read_b128 v[116:119], v208 offset:0
    ds_read_b128 v[120:123], v209 offset:0
    ds_read_b128 v[124:127], v208 offset:128
    ds_read_b128 v[128:131], v209 offset:128
    ds_read_b128 v[132:135], v208 offset:256
    ds_read_b128 v[136:139], v209 offset:256
    s_waitcnt lgkmcnt(0)
    v_mfma_f32_16x16x32_bf16 v[36:39], v[116:119], a[192:195], 0
    v_mfma_f32_16x16x32_bf16 v[36:39], v[120:123], a[196:199], v[36:39]
    v_mfma_f32_16x16x32_bf16 v[36:39], v[124:127], a[200:203], v[36:39]
    v_mfma_f32_16x16x32_bf16 v[36:39], v[128:131], a[204:207], v[36:39]
    v_mfma_f32_16x16x32_bf16 v[36:39], v[132:135], a[208:211], v[36:39]
    v_mfma_f32_16x16x32_bf16 v[36:39], v[136:139], a[212:215], v[36:39]
    v_mfma_f32_16x16x32_bf16 v[40:43], v[116:119], a[216:219], 0
    v_mfma_f32_16x16x32_bf16 v[40:43], v[120:123], a[220:223], v[40:43]
    v_mfma_f32_16x16x32_bf16 v[40:43], v[124:127], a[224:227], v[40:43]
    v_mfma_f32_16x16x32_bf16 v[40:43], v[128:131], a[228:231], v[40:43]
    v_mfma_f32_16x16x32_bf16 v[40:43], v[132:135], a[232:235], v[40:43]
    v_mfma_f32_16x16x32_bf16 v[40:43], v[136:139], a[236:239], v[40:43]
    v_mfma_f32_16x16x32_bf16 v[44:47], v[116:119], a[240:243], 0
    v_mfma_f32_16x16x32_bf16 v[44:47], v[120:123], a[244:247], v[44:47]
    v_mfma_f32_16x16x32_bf16 v[44:47], v[124:127], a[248:251], v[44:47]
    v_mfma_f32_16x16x32_bf16 v[44:47], v[128:131], a[252:255], v[44:47]
    v_mfma_f32_16x16x32_bf16 v[44:47], v[132:135], v[4:7], v[44:47]
    v_mfma_f32_16x16x32_bf16 v[44:47], v[136:139], v[8:11], v[44:47]
    v_mfma_f32_16x16x32_bf16 v[48:51], v[116:119], v[12:15], 0
    v_mfma_f32_16x16x32_bf16 v[48:51], v[120:123], v[16:19], v[48:51]
    v_mfma_f32_16x16x32_bf16 v[48:51], v[124:127], v[20:23], v[48:51]
    v_mfma_f32_16x16x32_bf16 v[48:51], v[128:131], v[24:27], v[48:51]
    v_mfma_f32_16x16x32_bf16 v[48:51], v[132:135], v[28:31], v[48:51]
    v_mfma_f32_16x16x32_bf16 v[48:51], v[136:139], v[32:35], v[48:51]
    s_nop 7
    v_max3_f32 v204, v36, v37, v204
    v_max3_f32 v204, v38, v39, v204
    v_max3_f32 v205, v40, v41, v205
    v_max3_f32 v205, v42, v43, v205
    v_max3_f32 v206, v44, v45, v206
    v_max3_f32 v206, v46, v47, v206
    v_max3_f32 v207, v48, v49, v207
    v_max3_f32 v207, v50, v51, v207
    ds_read_b128 v[140:143], v208 offset:6144
    ds_read_b128 v[144:147], v209 offset:6144
    ds_read_b128 v[148:151], v208 offset:6272
    ds_read_b128 v[152:155], v209 offset:6272
    ds_read_b128 v[156:159], v208 offset:6400
    ds_read_b128 v[160:163], v209 offset:6400
    s_waitcnt lgkmcnt(0)
    v_mfma_f32_16x16x32_bf16 v[36:39], v[140:143], a[192:195], 0
    v_mfma_f32_16x16x32_bf16 v[36:39], v[144:147], a[196:199], v[36:39]
    v_mfma_f32_16x16x32_bf16 v[36:39], v[148:151], a[200:203], v[36:39]
    v_mfma_f32_16x16x32_bf16 v[36:39], v[152:155], a[204:207], v[36:39]
    v_mfma_f32_16x16x32_bf16 v[36:39], v[156:159], a[208:211], v[36:39]
    v_mfma_f32_16x16x32_bf16 v[36:39], v[160:163], a[212:215], v[36:39]
    v_mfma_f32_16x16x32_bf16 v[40:43], v[140:143], a[216:219], 0
    v_mfma_f32_16x16x32_bf16 v[40:43], v[144:147], a[220:223], v[40:43]
    v_mfma_f32_16x16x32_bf16 v[40:43], v[148:151], a[224:227], v[40:43]
    v_mfma_f32_16x16x32_bf16 v[40:43], v[152:155], a[228:231], v[40:43]
    v_mfma_f32_16x16x32_bf16 v[40:43], v[156:159], a[232:235], v[40:43]
    v_mfma_f32_16x16x32_bf16 v[40:43], v[160:163], a[236:239], v[40:43]
    v_mfma_f32_16x16x32_bf16 v[44:47], v[140:143], a[240:243], 0
    v_mfma_f32_16x16x32_bf16 v[44:47], v[144:147], a[244:247], v[44:47]
    v_mfma_f32_16x16x32_bf16 v[44:47], v[148:151], a[248:251], v[44:47]
    v_mfma_f32_16x16x32_bf16 v[44:47], v[152:155], a[252:255], v[44:47]
    v_mfma_f32_16x16x32_bf16 v[44:47], v[156:159], v[4:7], v[44:47]
    v_mfma_f32_16x16x32_bf16 v[44:47], v[160:163], v[8:11], v[44:47]
    v_mfma_f32_16x16x32_bf16 v[48:51], v[140:143], v[12:15], 0
    v_mfma_f32_16x16x32_bf16 v[48:51], v[144:147], v[16:19], v[48:51]
    v_mfma_f32_16x16x32_bf16 v[48:51], v[148:151], v[20:23], v[48:51]
    v_mfma_f32_16x16x32_bf16 v[48:51], v[152:155], v[24:27], v[48:51]
    v_mfma_f32_16x16x32_bf16 v[48:51], v[156:159], v[28:31], v[48:51]
    v_mfma_f32_16x16x32_bf16 v[48:51], v[160:163], v[32:35], v[48:51]
    s_nop 7
    v_max3_f32 v204, v36, v37, v204
    v_max3_f32 v204, v38, v39, v204
    v_max3_f32 v205, v40, v41, v205
    v_max3_f32 v205, v42, v43, v205
    v_max3_f32 v206, v44, v45, v206
    v_max3_f32 v206, v46, v47, v206
    v_max3_f32 v207, v48, v49, v207
    v_max3_f32 v207, v50, v51, v207
    ds_read_b128 v[116:119], v208 offset:12288
    ds_read_b128 v[120:123], v209 offset:12288
    ds_read_b128 v[124:127], v208 offset:12416
    ds_read_b128 v[128:131], v209 offset:12416
    ds_read_b128 v[132:135], v208 offset:12544
    ds_read_b128 v[136:139], v209 offset:12544
    s_waitcnt lgkmcnt(0)
    v_mfma_f32_16x16x32_bf16 v[36:39], v[116:119], a[192:195], 0
    v_mfma_f32_16x16x32_bf16 v[36:39], v[120:123], a[196:199], v[36:39]
    v_mfma_f32_16x16x32_bf16 v[36:39], v[124:127], a[200:203], v[36:39]
    v_mfma_f32_16x16x32_bf16 v[36:39], v[128:131], a[204:207], v[36:39]
    v_mfma_f32_16x16x32_bf16 v[36:39], v[132:135], a[208:211], v[36:39]
    v_mfma_f32_16x16x32_bf16 v[36:39], v[136:139], a[212:215], v[36:39]
    v_mfma_f32_16x16x32_bf16 v[40:43], v[116:119], a[216:219], 0
    v_mfma_f32_16x16x32_bf16 v[40:43], v[120:123], a[220:223], v[40:43]
    v_mfma_f32_16x16x32_bf16 v[40:43], v[124:127], a[224:227], v[40:43]
    v_mfma_f32_16x16x32_bf16 v[40:43], v[128:131], a[228:231], v[40:43]
    v_mfma_f32_16x16x32_bf16 v[40:43], v[132:135], a[232:235], v[40:43]
    v_mfma_f32_16x16x32_bf16 v[40:43], v[136:139], a[236:239], v[40:43]
    v_mfma_f32_16x16x32_bf16 v[44:47], v[116:119], a[240:243], 0
    v_mfma_f32_16x16x32_bf16 v[44:47], v[120:123], a[244:247], v[44:47]
    v_mfma_f32_16x16x32_bf16 v[44:47], v[124:127], a[248:251], v[44:47]
    v_mfma_f32_16x16x32_bf16 v[44:47], v[128:131], a[252:255], v[44:47]
    v_mfma_f32_16x16x32_bf16 v[44:47], v[132:135], v[4:7], v[44:47]
    v_mfma_f32_16x16x32_bf16 v[44:47], v[136:139], v[8:11], v[44:47]
    v_mfma_f32_16x16x32_bf16 v[48:51], v[116:119], v[12:15], 0
    v_mfma_f32_16x16x32_bf16 v[48:51], v[120:123], v[16:19], v[48:51]
    v_mfma_f32_16x16x32_bf16 v[48:51], v[124:127], v[20:23], v[48:51]
    v_mfma_f32_16x16x32_bf16 v[48:51], v[128:131], v[24:27], v[48:51]
    v_mfma_f32_16x16x32_bf16 v[48:51], v[132:135], v[28:31], v[48:51]
    v_mfma_f32_16x16x32_bf16 v[48:51], v[136:139], v[32:35], v[48:51]
    s_nop 7
    v_max3_f32 v204, v36, v37, v204
    v_max3_f32 v204, v38, v39, v204
    v_max3_f32 v205, v40, v41, v205
    v_max3_f32 v205, v42, v43, v205
    v_max3_f32 v206, v44, v45, v206
    v_max3_f32 v206, v46, v47, v206
    v_max3_f32 v207, v48, v49, v207
    v_max3_f32 v207, v50, v51, v207
    ds_read_b128 v[140:143], v208 offset:18432
    ds_read_b128 v[144:147], v209 offset:18432
    ds_read_b128 v[148:151], v208 offset:18560
    ds_read_b128 v[152:155], v209 offset:18560
    ds_read_b128 v[156:159], v208 offset:18688
    ds_read_b128 v[160:163], v209 offset:18688
    s_waitcnt lgkmcnt(0)
    v_mfma_f32_16x16x32_bf16 v[36:39], v[140:143], a[192:195], 0
    v_mfma_f32_16x16x32_bf16 v[36:39], v[144:147], a[196:199], v[36:39]
    v_mfma_f32_16x16x32_bf16 v[36:39], v[148:151], a[200:203], v[36:39]
    v_mfma_f32_16x16x32_bf16 v[36:39], v[152:155], a[204:207], v[36:39]
    v_mfma_f32_16x16x32_bf16 v[36:39], v[156:159], a[208:211], v[36:39]
    v_mfma_f32_16x16x32_bf16 v[36:39], v[160:163], a[212:215], v[36:39]
    v_mfma_f32_16x16x32_bf16 v[40:43], v[140:143], a[216:219], 0
    v_mfma_f32_16x16x32_bf16 v[40:43], v[144:147], a[220:223], v[40:43]
    v_mfma_f32_16x16x32_bf16 v[40:43], v[148:151], a[224:227], v[40:43]
    v_mfma_f32_16x16x32_bf16 v[40:43], v[152:155], a[228:231], v[40:43]
    v_mfma_f32_16x16x32_bf16 v[40:43], v[156:159], a[232:235], v[40:43]
    v_mfma_f32_16x16x32_bf16 v[40:43], v[160:163], a[236:239], v[40:43]
    v_mfma_f32_16x16x32_bf16 v[44:47], v[140:143], a[240:243], 0
    v_mfma_f32_16x16x32_bf16 v[44:47], v[144:147], a[244:247], v[44:47]
    v_mfma_f32_16x16x32_bf16 v[44:47], v[148:151], a[248:251], v[44:47]
    v_mfma_f32_16x16x32_bf16 v[44:47], v[152:155], a[252:255], v[44:47]
    v_mfma_f32_16x16x32_bf16 v[44:47], v[156:159], v[4:7], v[44:47]
    v_mfma_f32_16x16x32_bf16 v[44:47], v[160:163], v[8:11], v[44:47]
    v_mfma_f32_16x16x32_bf16 v[48:51], v[140:143], v[12:15], 0
    v_mfma_f32_16x16x32_bf16 v[48:51], v[144:147], v[16:19], v[48:51]
    v_mfma_f32_16x16x32_bf16 v[48:51], v[148:151], v[20:23], v[48:51]
    v_mfma_f32_16x16x32_bf16 v[48:51], v[152:155], v[24:27], v[48:51]
    v_mfma_f32_16x16x32_bf16 v[48:51], v[156:159], v[28:31], v[48:51]
    v_mfma_f32_16x16x32_bf16 v[48:51], v[160:163], v[32:35], v[48:51]
    s_nop 7
    v_max3_f32 v204, v36, v37, v204
    v_max3_f32 v204, v38, v39, v204
    v_max3_f32 v205, v40, v41, v205
    v_max3_f32 v205, v42, v43, v205
    v_max3_f32 v206, v44, v45, v206
    v_max3_f32 v206, v46, v47, v206
    v_max3_f32 v207, v48, v49, v207
    v_max3_f32 v207, v50, v51, v207
    s_barrier
    s_add_u32 s24, s24, 24576
    s_add_u32 s26, s26, 24576
    s_cmp_lt_u32 s24, 786432
    s_cbranch_scc1 L_fb
    v_mov_b32 v231, v204
    s_nop 1
    v_permlane32_swap_b32 v231, v204
    s_nop 0
    v_max_f32 v204, v231, v204
    v_mov_b32 v231, v204
    s_nop 1
    v_permlane16_swap_b32 v231, v204
    s_nop 0
    v_max_f32 v204, v231, v204
    v_sub_f32 v188, 0, v204
    v_sub_f32 v189, 0, v204
    v_sub_f32 v190, 0, v204
    v_sub_f32 v191, 0, v204
    v_mov_b32 v231, v205
    s_nop 1
    v_permlane32_swap_b32 v231, v205
    s_nop 0
    v_max_f32 v205, v231, v205
    v_mov_b32 v231, v205
    s_nop 1
    v_permlane16_swap_b32 v231, v205
    s_nop 0
    v_max_f32 v205, v231, v205
    v_sub_f32 v192, 0, v205
    v_sub_f32 v193, 0, v205
    v_sub_f32 v194, 0, v205
    v_sub_f32 v195, 0, v205
    v_mov_b32 v231, v206
    s_nop 1
    v_permlane32_swap_b32 v231, v206
    s_nop 0
    v_max_f32 v206, v231, v206
    v_mov_b32 v231, v206
    s_nop 1
    v_permlane16_swap_b32 v231, v206
    s_nop 0
    v_max_f32 v206, v231, v206
    v_sub_f32 v196, 0, v206
    v_sub_f32 v197, 0, v206
    v_sub_f32 v198, 0, v206
    v_sub_f32 v199, 0, v206
    v_mov_b32 v231, v207
    s_nop 1
    v_permlane32_swap_b32 v231, v207
    s_nop 0
    v_max_f32 v207, v231, v207
    v_mov_b32 v231, v207
    s_nop 1
    v_permlane16_swap_b32 v231, v207
    s_nop 0
    v_max_f32 v207, v231, v207
    v_sub_f32 v200, 0, v207
    v_sub_f32 v201, 0, v207
    v_sub_f32 v202, 0, v207
    v_sub_f32 v203, 0, v207
    v_mov_b32 v204, 0
    v_mov_b32 v205, 0
    v_mov_b32 v206, 0
    v_mov_b32 v207, 0
    v_mbcnt_lo_u32_b32 v220, -1, 0
    v_mbcnt_hi_u32_b32 v220, -1, v220
    v_and_b32 v224, 15, v220
    v_lshrrev_b32 v221, 4, v220
    v_and_b32 v222, 6, v224
    v_xor_b32 v221, v221, v222
    v_mul_u32_u24 v223, 0x180, v224
    v_lshl_add_u32 v208, v221, 4, v223
    v_xor_b32 v221, 4, v221
    v_lshl_add_u32 v209, v221, 4, v223
    v_lshrrev_b32 v224, 2, v220
    v_mul_u32_u24 v223, 0x180, v224
    v_and_b32 v221, 1, v220
    v_lshl_add_u32 v223, v221, 3, v223
    v_add_u32 v223, 73728, v223
    v_bfe_u32 v221, v220, 1, 1
    v_and_b32 v222, 6, v224
    v_xor_b32 v221, v221, v222
    v_xor_b32 v222, 0, v221
    v_lshl_add_u32 v210, v222, 4, v223
    v_xor_b32 v222, 2, v221
    v_lshl_add_u32 v211, v222, 4, v223
    v_xor_b32 v222, 4, v221
    v_lshl_add_u32 v212, v222, 4, v223
    v_xor_b32 v222, 6, v221
    v_lshl_add_u32 v213, v222, 4, v223
    v_mov_b32 v252, 0
    v_mov_b32 v253, 0
    v_mov_b32 v254, 0
    v_mov_b32 v255, 0
    s_mov_b32 s24, 737280
    s_mov_b32 s26, 740352
    s_add_u32 s28, s60, 0
    s_mov_b32 m0, s28
    s_nop 0
    buffer_load_dwordx4 v214, s[12:15], s24 offen offset:0 lds
    buffer_load_dwordx4 v215, s[12:15], s24 offen offset:1024 lds
    buffer_load_dwordx4 v216, s[12:15], s24 offen offset:2048 lds
    s_add_u32 m0, s28, 3072
    s_nop 0
    buffer_load_dwordx4 v214, s[12:15], s26 offen offset:0 lds
    buffer_load_dwordx4 v215, s[12:15], s26 offen offset:1024 lds
    buffer_load_dwordx4 v216, s[12:15], s26 offen offset:2048 lds
    v_mfma_f32_32x32x16_bf16 a[0:15], v[204:207], v[204:207], 0
    v_mfma_f32_32x32x16_bf16 a[16:31], v[204:207], v[204:207], 0
    v_mfma_f32_32x32x16_bf16 a[32:47], v[204:207], v[204:207], 0
    v_mfma_f32_32x32x16_bf16 a[48:63], v[204:207], v[204:207], 0
    v_mfma_f32_32x32x16_bf16 a[64:79], v[204:207], v[204:207], 0
    v_mfma_f32_32x32x16_bf16 a[80:95], v[204:207], v[204:207], 0
    v_mfma_f32_32x32x16_bf16 a[96:111], v[204:207], v[204:207], 0
    v_mfma_f32_32x32x16_bf16 a[112:127], v[204:207], v[204:207], 0
    v_mfma_f32_32x32x16_bf16 a[128:143], v[204:207], v[204:207], 0
    v_mfma_f32_32x32x16_bf16 a[144:159], v[204:207], v[204:207], 0
    v_mfma_f32_32x32x16_bf16 a[160:175], v[204:207], v[204:207], 0
    v_mfma_f32_32x32x16_bf16 a[176:191], v[204:207], v[204:207], 0
    s_mov_b32 s25, 737280
    s_mov_b32 s27, 740352
    s_add_u32 s29, s60, 73728
    s_mov_b32 m0, s29
    s_nop 0
    buffer_load_dwordx4 v214, s[16:19], s25 offen offset:0 lds
    buffer_load_dwordx4 v215, s[16:19], s25 offen offset:1024 lds
    buffer_load_dwordx4 v216, s[16:19], s25 offen offset:2048 lds
    s_add_u32 m0, s29, 3072
    s_nop 0
    buffer_load_dwordx4 v214, s[16:19], s27 offen offset:0 lds
    buffer_load_dwordx4 v215, s[16:19], s27 offen offset:1024 lds
    buffer_load_dwordx4 v216, s[16:19], s27 offen offset:2048 lds
    s_mov_b32 s24, 761856
    s_mov_b32 s26, 764928
    s_add_u32 s28, s60, 24576
    s_mov_b32 m0, s28
    s_nop 0
    buffer_load_dwordx4 v214, s[12:15], s24 offen offset:0 lds
    buffer_load_dwordx4 v215, s[12:15], s24 offen offset:1024 lds
    buffer_load_dwordx4 v216, s[12:15], s24 offen offset:2048 lds
    s_add_u32 m0, s28, 3072
    s_nop 0
    buffer_load_dwordx4 v214, s[12:15], s26 offen offset:0 lds
    buffer_load_dwordx4 v215, s[12:15], s26 offen offset:1024 lds
    buffer_load_dwordx4 v216, s[12:15], s26 offen offset:2048 lds
    s_mov_b32 s24, 0
    s_mov_b32 s26, 3072
    s_add_u32 s28, s60, 49152
    s_mov_b32 m0, s28
    s_nop 0
    buffer_load_dwordx4 v214, s[12:15], s24 offen offset:0 lds
    buffer_load_dwordx4 v215, s[12:15], s24 offen offset:1024 lds
    buffer_load_dwordx4 v216, s[12:15], s24 offen offset:2048 lds
    s_add_u32 m0, s28, 3072
    s_nop 0
    buffer_load_dwordx4 v214, s[12:15], s26 offen offset:0 lds
    buffer_load_dwordx4 v215, s[12:15], s26 offen offset:1024 lds
    buffer_load_dwordx4 v216, s[12:15], s26 offen offset:2048 lds
    s_mov_b32 s25, 761856
    s_mov_b32 s27, 764928
    s_add_u32 s29, s60, 98304
    s_mov_b32 m0, s29
    s_nop 0
    buffer_load_dwordx4 v214, s[16:19], s25 offen offset:0 lds
    buffer_load_dwordx4 v215, s[16:19], s25 offen offset:1024 lds
    buffer_load_dwordx4 v216, s[16:19], s25 offen offset:2048 lds
    s_add_u32 m0, s29, 3072
    s_nop 0
    buffer_load_dwordx4 v214, s[16:19], s27 offen offset:0 lds
    buffer_load_dwordx4 v215, s[16:19], s27 offen offset:1024 lds
    buffer_load_dwordx4 v216, s[16:19], s27 offen offset:2048 lds
    s_mov_b32 s39, 0xffff0000
    s_waitcnt vmcnt(0)
    s_barrier
    ds_read_b128 v[116:119], v208 offset:0
    ds_read_b128 v[120:123], v209 offset:0
    ds_read_b128 v[124:127], v208 offset:128
    ds_read_b128 v[128:131], v209 offset:128
    ds_read_b128 v[132:135], v208 offset:256
    ds_read_b128 v[136:139], v209 offset:256
    s_waitcnt lgkmcnt(0)
    s_branch L_main

    s_branch L_join
L_end:
    s_endpgm
.section .rodata,"a"
.p2align 6
.amdhsa_kernel standalone__mha_softmax__prompt_kernel
  .amdhsa_next_free_vgpr 512
  .amdhsa_next_free_sgpr 102
  .amdhsa_accum_offset 256
  .amdhsa_group_segment_fixed_size 0
  .amdhsa_kernarg_size 48
  .amdhsa_user_sgpr_count 2
  .amdhsa_user_sgpr_kernarg_segment_ptr 1
  .amdhsa_system_sgpr_workgroup_id_x 1
.end_amdhsa_kernel
```
